```python
import torch

def _softmax(x, axis=-1):
    return torch.softmax(x, dim=axis)
def _gelu(x):
    return torch.nn.functional.gelu(x, approximate="tanh")
def _silu(x):
    return torch.nn.functional.silu(x)
def _sigmoid(x):
    return torch.sigmoid(x)
def _layernorm(x, axis=-1, eps=1e-5):
    m = x.mean(dim=axis, keepdim=True)
    v = x.var(dim=axis, keepdim=True, unbiased=False)
    return (x - m) / torch.sqrt(v + eps)
def _scatter_add(tgt, idx, src, axis=0):
    return tgt.clone().index_add_(axis, idx, src)
def _segment_sum(src, seg, n):
    out = torch.zeros((n,) + src.shape[1:], dtype=src.dtype)
    return out.index_add_(0, seg, src)
def _pad(x, pw):
    flat = tuple(v for pair in reversed(pw) for v in pair)
    return torch.nn.functional.pad(x, flat)

kernel_name = 'gated_mix__spectral_fnet__glu_gated_glu__prompt'

def setup_inputs():

    _w = (lambda a: (lambda t: t.to(torch.bfloat16) if t.is_floating_point() else t)(torch.as_tensor(a)))
    def _A_setup():
        B, S, D = 1, 2048, 448
        ns = torch.arange(S)[:, None] * torch.arange(S)[None, :]
        nd = torch.arange(D)[:, None] * torch.arange(D)[None, :]
        Ws_re = torch.cos(-2.0 * torch.pi * ns / S).to(float)
        Ws_im = torch.sin(-2.0 * torch.pi * ns / S).to(float)
        Wd_re = torch.cos(-2.0 * torch.pi * nd / D).to(float)
        Wd_im = torch.sin(-2.0 * torch.pi * nd / D).to(float)
        return {
            "x": _w((lambda *s: torch.randn(*s, dtype=torch.bfloat16) * 0.05)(B, S, D)),
            "dft_seq_re": _w(Ws_re),
            "dft_seq_im": _w(Ws_im),
            "dft_hid_re": _w(Wd_re),
            "dft_hid_im": _w(Wd_im),
        }
    _A_in = _A_setup()

    def _B_setup():
        B, S, D, F = 1, 2048, 448, 1792
        return {
            "x": _w((lambda *s: torch.randn(*s, dtype=torch.bfloat16) * 0.05)(B, S, D)),
            "w_gate": _w((lambda *s: torch.randn(*s, dtype=torch.bfloat16) * 1.6)(D, F)),
            "w_up": _w((lambda *s: torch.randn(*s, dtype=torch.bfloat16) * 0.8)(D, F)),
            "w_down": _w((lambda *s: torch.randn(*s, dtype=torch.bfloat16) * 0.8)(F, D)),
        }
    _B_in = _B_setup()

    return {
        "A_x": _A_in["x"],
        "A_dft_seq_re": _A_in["dft_seq_re"],
        "A_dft_seq_im": _A_in["dft_seq_im"],
        "A_dft_hid_re": _A_in["dft_hid_re"],
        "A_dft_hid_im": _A_in["dft_hid_im"],
        "B_x": _B_in["x"],
        "B_w_gate": _B_in["w_gate"],
        "B_w_up": _B_in["w_up"],
        "B_w_down": _B_in["w_down"],
        "gate_w": _w((lambda *s: torch.randn(*s, dtype=torch.bfloat16) * 0.05)(448) * 16.0),
    }

def reference(A_x, A_dft_seq_re, A_dft_seq_im, A_dft_hid_re, A_dft_hid_im, B_x, B_w_gate, B_w_up, B_w_down, gate_w):
    def _A_ref(x, dft_seq_re, dft_seq_im, dft_hid_re, dft_hid_im):
        a = torch.einsum("bsd,ed->bse", x, dft_hid_re)
        b = torch.einsum("bsd,ed->bse", x, dft_hid_im)
        y = torch.einsum("ts,bse->bte", dft_seq_re, a) - torch.einsum("ts,bse->bte", dft_seq_im, b)
        return y

    def _B_ref(x, w_gate, w_up, w_down):
        g = torch.einsum("bsd,df->bsf", x, w_gate)
        u = torch.einsum("bsd,df->bsf", x, w_up)
        h = _sigmoid(g) * u
        return torch.einsum("bsf,fd->bsd", h, w_down)

    x = A_x
    g = _sigmoid((x * gate_w).sum(-1, keepdims=True))
    a = _A_ref(x, A_dft_seq_re, A_dft_seq_im, A_dft_hid_re, A_dft_hid_im)
    b = _B_ref(x, B_w_gate, B_w_up, B_w_down)
    return g * a + (1 - g) * b
```

```asm
; @launch grid=(256,1,1) block=(512,1,1) lds=163840
.amdgcn_target "amdgcn-amd-amdhsa--gfx950"
.text
.globl gated_mix__spectral_fnet__glu_gated_glu__prompt_kernel
.p2align 8
.type gated_mix__spectral_fnet__glu_gated_glu__prompt_kernel,@function
gated_mix__spectral_fnet__glu_gated_glu__prompt_kernel:
    s_cmp_ge_u32 s2, 256
    s_cbranch_scc1 KF_END
    s_load_dwordx2 s[44:45], s[0:1], 0
    s_load_dwordx4 s[48:51], s[0:1], 24
    s_load_dwordx4 s[52:55], s[0:1], 48
    s_load_dwordx4 s[56:59], s[0:1], 64
    s_load_dwordx2 s[46:47], s[0:1], 80
    s_load_dwordx4 s[72:75], s[0:1], 88
    v_and_b32 v1, 63, v0
    v_lshrrev_b32 v2, 6, v0
    s_nop 0
    v_readfirstlane_b32 s40, v2
    s_nop 3
    s_and_b32 s64, s40, 3
    s_and_b32 s65, s40, 3
    s_and_b32 s41, s2, 7
    s_lshr_b32 s42, s2, 3
    s_cmp_ge_u32 s42, 28
    s_cbranch_scc1 P1_DFT
    s_mul_i32 s43, s42, 37
    s_lshr_b32 s43, s43, 8
    s_mul_i32 s76, s43, 7
    s_sub_u32 s76, s42, s76
    s_lshr_b32 s77, s41, 1
    s_lshl_b32 s77, s77, 2
    s_add_u32 s60, s77, s43
    s_and_b32 s77, s41, 1
    s_mul_i32 s77, s77, 7
    s_add_u32 s61, s77, s76
    s_cmp_lt_u32 s40, 4
    s_cbranch_scc1 P1_H_CONSUMER
    v_lshrrev_b32 v26, 3, v1
    v_and_b32 v27, 7, v1
    v_lshrrev_b32 v28, 4, v1
    v_xor_b32 v29, v27, v28
    v_lshlrev_b32 v29, 4, v29
    v_mul_u32_u24 v30, 28672, v26
    s_lshl_b32 s41, s60, 1
    s_lshr_b32 s42, s65, 1
    s_add_u32 s41, s41, s42
    s_mul_i32 s41, s41, 896
    s_and_b32 s42, s65, 1
    s_mul_i32 s42, s42, 917504
    s_add_u32 s41, s41, s42
    v_add3_u32 v10, v30, v29, s41
    v_xor_b32 v29, 64, v29
    s_add_u32 s42, s41, 228352
    v_add3_u32 v11, v30, v29, s42
    v_add_u32 v12, 456704, v10
    v_add_u32 v13, 456704, v11
    v_mul_u32_u24 v30, 3584, v26
    v_and_b32 v28, 1, v28
    v_lshlrev_b32 v28, 2, v28
    v_xor_b32 v28, v28, v27
    v_lshlrev_b32 v28, 4, v28
    s_mul_i32 s41, s65, 28672
    s_lshl_b32 s42, s61, 7
    s_add_u32 s41, s41, s42
    v_add3_u32 v14, v30, v28, s41
    v_add_u32 v15, 114688, v14
    s_lshl_b32 s66, s65, 11
    s_lshl_b32 s67, s65, 12
    s_mul_i32 s6, s60, 2
    s_mul_i32 s7, s61, 1
    s_add_u32 s6, s6, s7
    s_mul_i32 s7, s6, 37
    s_lshr_b32 s7, s7, 8
    s_mul_i32 s7, s7, 7
    s_sub_u32 s6, s6, s7
    s_waitcnt lgkmcnt(0)
    s_mov_b32 s8, s44
    s_and_b32 s9, s45, 0xffff
    s_mov_b32 s10, 0x1c0000
    s_mov_b32 s11, 0x20000
    s_mov_b32 s12, s52
    s_and_b32 s13, s53, 0xffff
    s_mov_b32 s14, 0x188000
    s_mov_b32 s15, 0x20000
    s_sub_u32 s16, s54, 1024
    s_subb_u32 s17, s55, 0
    s_and_b32 s17, s17, 0xffff
    s_mov_b32 s18, 0x188400
    s_mov_b32 s19, 0x20000
    s_mov_b64 s[76:77], s[56:57]
    s_mov_b64 s[78:79], s[58:59]
    s_lshl_b32 s44, s6, 7
    s_mul_i32 s51, s6, 229376
    s_add_u32 m0, s67, 0x0
    s_nop 0
    buffer_load_dwordx4 v10, s[8:11], s44 offen offset:0 lds
    buffer_load_dwordx4 v11, s[8:11], s44 offen offset:1024 lds
    buffer_load_dwordx4 v12, s[8:11], s44 offen offset:2048 lds
    buffer_load_dwordx4 v13, s[8:11], s44 offen offset:3072 lds
    s_add_u32 m0, s66, 0x1c000
    s_nop 0
    buffer_load_dwordx4 v14, s[12:15], s51 offen offset:0 lds
    buffer_load_dwordx4 v14, s[16:19], s51 offen offset:1024 lds
    s_add_u32 m0, s66, 0x1e000
    s_nop 0
    buffer_load_dwordx4 v15, s[12:15], s51 offen offset:0 lds
    buffer_load_dwordx4 v15, s[16:19], s51 offen offset:1024 lds
    v_add_u32 v16, 1792, v14
    v_add_u32 v17, 1792, v15
    s_mov_b32 s20, s74
    s_and_b32 s21, s75, 0xffff
    s_mov_b32 s22, 0x1000000
    s_mov_b32 s23, 0x20000
    s_mov_b32 s32, s76
    s_and_b32 s33, s77, 0xffff
    s_mov_b32 s34, 0x188000
    s_mov_b32 s35, 0x20000
    s_mov_b32 s24, s78
    s_and_b32 s25, s79, 0xffff
    s_mov_b32 s26, 0x380
    s_mov_b32 s27, 0x20000
    s_mov_b32 s36, s72
    s_and_b32 s37, s73, 0xffff
    s_mov_b32 s38, 0x100
    s_mov_b32 s39, 0x20000
    s_lshl_b32 s41, s60, 9
    s_lshl_b32 s42, s61, 2
    s_add_u32 s41, s41, s42
    s_add_u32 s99, s41, 0x910000
    v_mov_b32 v7, 0
    s_add_u32 s6, s6, 1
    s_cmp_eq_u32 s6, 7
    s_cselect_b32 s6, 0, s6
    s_lshl_b32 s45, s6, 7
    s_mul_i32 s52, s6, 229376
    s_add_u32 m0, s67, 0x4000
    s_nop 0
    buffer_load_dwordx4 v10, s[8:11], s45 offen offset:0 lds
    buffer_load_dwordx4 v11, s[8:11], s45 offen offset:1024 lds
    buffer_load_dwordx4 v12, s[8:11], s45 offen offset:2048 lds
    buffer_load_dwordx4 v13, s[8:11], s45 offen offset:3072 lds
    s_add_u32 m0, s66, 0x20000
    s_nop 0
    buffer_load_dwordx4 v14, s[12:15], s52 offen offset:0 lds
    buffer_load_dwordx4 v14, s[16:19], s52 offen offset:1024 lds
    s_add_u32 m0, s66, 0x22000
    s_nop 0
    buffer_load_dwordx4 v15, s[12:15], s52 offen offset:0 lds
    buffer_load_dwordx4 v15, s[16:19], s52 offen offset:1024 lds
    s_add_u32 s6, s6, 1
    s_cmp_eq_u32 s6, 7
    s_cselect_b32 s6, 0, s6
    s_lshl_b32 s46, s6, 7
    s_mul_i32 s53, s6, 229376
    s_add_u32 m0, s67, 0x8000
    s_nop 0
    buffer_load_dwordx4 v10, s[8:11], s46 offen offset:0 lds
    buffer_load_dwordx4 v11, s[8:11], s46 offen offset:1024 lds
    buffer_load_dwordx4 v12, s[8:11], s46 offen offset:2048 lds
    buffer_load_dwordx4 v13, s[8:11], s46 offen offset:3072 lds
    s_add_u32 m0, s66, 0x24000
    s_nop 0
    buffer_load_dwordx4 v14, s[12:15], s53 offen offset:0 lds
    buffer_load_dwordx4 v14, s[16:19], s53 offen offset:1024 lds
    s_add_u32 m0, s66, 0x26000
    s_nop 0
    buffer_load_dwordx4 v15, s[12:15], s53 offen offset:0 lds
    buffer_load_dwordx4 v15, s[16:19], s53 offen offset:1024 lds
    s_waitcnt vmcnt(16)
    s_barrier
    s_add_u32 s6, s6, 1
    s_cmp_eq_u32 s6, 7
    s_cselect_b32 s6, 0, s6
    s_lshl_b32 s47, s6, 7
    s_mul_i32 s54, s6, 229376
    s_add_u32 m0, s67, 0xc000
    s_nop 0
    buffer_load_dwordx4 v10, s[8:11], s47 offen offset:0 lds
    buffer_load_dwordx4 v11, s[8:11], s47 offen offset:1024 lds
    buffer_load_dwordx4 v12, s[8:11], s47 offen offset:2048 lds
    buffer_load_dwordx4 v13, s[8:11], s47 offen offset:3072 lds
    s_waitcnt vmcnt(14)
    s_barrier
    s_add_u32 m0, s66, 0x1c000
    s_nop 0
    buffer_load_dwordx4 v14, s[12:15], s54 offen offset:0 lds
    buffer_load_dwordx4 v14, s[16:19], s54 offen offset:1024 lds
    s_and_b32 s41, s2, 7
    s_lshr_b32 s42, s2, 3
    s_mul_i32 s43, s42, 37
    s_lshr_b32 s43, s43, 8
    s_mul_i32 s76, s43, 7
    s_sub_u32 s71, s42, s76
    s_lshl_b32 s41, s41, 2
    s_add_u32 s70, s41, s43
    s_and_b32 s3, s40, 3
    v_lshrrev_b32 v2, 3, v1
    v_bfe_u32 v3, v1, 4, 1
    v_lshlrev_b32 v3, 2, v3
    v_and_b32 v8, 7, v1
    v_xor_b32 v3, v3, v8
    v_lshlrev_b32 v3, 4, v3
    s_mul_i32 s41, s3, 224
    v_add_u32 v2, s41, v2
    s_movk_i32 s42, 896
    v_mul_lo_u32 v2, v2, s42
    s_lshl_b32 s41, s71, 7
    v_add3_u32 v26, v2, v3, s41
    v_add_u32 v27, 6144, v26
    v_add_u32 v28, 12288, v26
    v_add_u32 v29, 18432, v26
    s_lshl_b32 s62, s3, 12
    s_and_b32 s4, s70, 3
    s_lshl_b32 s4, s4, 1
    s_add_u32 s4, s4, s71
    s_cmp_ge_u32 s4, 7
    s_cselect_b32 s5, 7, 0
    s_sub_u32 s4, s4, s5
    s_mov_b32 s4, 0
    s_waitcnt vmcnt(14)
    s_barrier
    s_add_u32 m0, s66, 0x1e000
    s_nop 0
    buffer_load_dwordx4 v15, s[12:15], s54 offen offset:0 lds
    buffer_load_dwordx4 v15, s[16:19], s54 offen offset:1024 lds
    s_add_u32 s6, s6, 1
    s_cmp_eq_u32 s6, 7
    s_cselect_b32 s6, 0, s6
    s_lshl_b32 s48, s6, 7
    s_mul_i32 s55, s6, 229376
    s_add_u32 m0, s67, 0x10000
    s_nop 0
    buffer_load_dwordx4 v10, s[8:11], s48 offen offset:0 lds
    buffer_load_dwordx4 v11, s[8:11], s48 offen offset:1024 lds
    buffer_load_dwordx4 v12, s[8:11], s48 offen offset:2048 lds
    buffer_load_dwordx4 v13, s[8:11], s48 offen offset:3072 lds
    s_waitcnt vmcnt(14)
    s_barrier
    s_add_u32 m0, s66, 0x20000
    s_nop 0
    buffer_load_dwordx4 v14, s[12:15], s55 offen offset:0 lds
    buffer_load_dwordx4 v14, s[16:19], s55 offen offset:1024 lds
    s_waitcnt vmcnt(14)
    s_barrier
    s_add_u32 m0, s66, 0x22000
    s_nop 0
    buffer_load_dwordx4 v15, s[12:15], s55 offen offset:0 lds
    buffer_load_dwordx4 v15, s[16:19], s55 offen offset:1024 lds
    s_add_u32 s6, s6, 1
    s_cmp_eq_u32 s6, 7
    s_cselect_b32 s6, 0, s6
    s_lshl_b32 s49, s6, 7
    s_mul_i32 s56, s6, 229376
    s_add_u32 m0, s67, 0x14000
    s_nop 0
    buffer_load_dwordx4 v10, s[8:11], s49 offen offset:0 lds
    buffer_load_dwordx4 v11, s[8:11], s49 offen offset:1024 lds
    buffer_load_dwordx4 v12, s[8:11], s49 offen offset:2048 lds
    buffer_load_dwordx4 v13, s[8:11], s49 offen offset:3072 lds
    s_waitcnt vmcnt(14)
    s_barrier
    s_add_u32 m0, s66, 0x24000
    s_nop 0
    buffer_load_dwordx4 v14, s[12:15], s56 offen offset:0 lds
    buffer_load_dwordx4 v14, s[16:19], s56 offen offset:1024 lds
    s_waitcnt vmcnt(14)
    s_barrier
    s_add_u32 m0, s66, 0x26000
    s_nop 0
    buffer_load_dwordx4 v15, s[12:15], s56 offen offset:0 lds
    buffer_load_dwordx4 v15, s[16:19], s56 offen offset:1024 lds
    s_add_u32 s6, s6, 1
    s_cmp_eq_u32 s6, 7
    s_cselect_b32 s6, 0, s6
    s_lshl_b32 s50, s6, 7
    s_mul_i32 s57, s6, 229376
    s_add_u32 m0, s67, 0x18000
    s_nop 0
    buffer_load_dwordx4 v10, s[8:11], s50 offen offset:0 lds
    buffer_load_dwordx4 v11, s[8:11], s50 offen offset:1024 lds
    buffer_load_dwordx4 v12, s[8:11], s50 offen offset:2048 lds
    buffer_load_dwordx4 v13, s[8:11], s50 offen offset:3072 lds
    s_waitcnt vmcnt(14)
    s_barrier
    s_add_u32 m0, s66, 0x1c000
    s_nop 0
    buffer_load_dwordx4 v14, s[12:15], s57 offen offset:0 lds
    buffer_load_dwordx4 v14, s[16:19], s57 offen offset:1024 lds
    s_waitcnt vmcnt(14)
    s_barrier
    s_add_u32 m0, s66, 0x1e000
    s_nop 0
    buffer_load_dwordx4 v15, s[12:15], s57 offen offset:0 lds
    buffer_load_dwordx4 v15, s[16:19], s57 offen offset:1024 lds
    s_waitcnt vmcnt(10)
    s_barrier
    s_add_u32 m0, s66, 0x20000
    s_nop 0
    buffer_load_dwordx4 v16, s[12:15], s51 offen offset:0 lds
    buffer_load_dwordx4 v16, s[16:19], s51 offen offset:1024 lds
    buffer_load_dword v4, v7, s[36:39], 0 offen sc1
    s_waitcnt vmcnt(11)
    s_barrier
    s_add_u32 m0, s66, 0x22000
    s_nop 0
    buffer_load_dwordx4 v17, s[12:15], s51 offen offset:0 lds
    buffer_load_dwordx4 v17, s[16:19], s51 offen offset:1024 lds
    s_waitcnt vmcnt(7)
    s_barrier
    s_add_u32 m0, s66, 0x24000
    s_nop 0
    buffer_load_dwordx4 v16, s[12:15], s52 offen offset:0 lds
    buffer_load_dwordx4 v16, s[16:19], s52 offen offset:1024 lds
    s_waitcnt vmcnt(7)
    s_barrier
    s_add_u32 m0, s66, 0x26000
    s_nop 0
    buffer_load_dwordx4 v17, s[12:15], s52 offen offset:0 lds
    buffer_load_dwordx4 v17, s[16:19], s52 offen offset:1024 lds
    s_waitcnt vmcnt(7)
    s_barrier
    s_add_u32 m0, s66, 0x1c000
    s_nop 0
    buffer_load_dwordx4 v16, s[12:15], s53 offen offset:0 lds
    buffer_load_dwordx4 v16, s[16:19], s53 offen offset:1024 lds
    s_waitcnt vmcnt(8)
    s_mov_b32 s42, 0
    s_branch NCK_3
NTA_2:
    s_waitcnt vmcnt(0)
NCK_3:
    v_readfirstlane_b32 s98, v4
    s_nop 3
    s_cmp_lg_u32 s98, 0
    s_cbranch_scc1 NFA_1
    s_add_u32 s42, s42, 1
    s_cmp_ge_u32 s42, 0x40000
    s_cbranch_scc1 NFA_1
    s_sleep 1
    buffer_load_dword v4, v7, s[36:39], 0 offen sc1
    s_branch NTA_2
NFA_1:
    s_waitcnt vmcnt(6)
    s_barrier
    s_add_u32 m0, s66, 0x1e000
    s_nop 0
    buffer_load_dwordx4 v17, s[12:15], s53 offen offset:0 lds
    buffer_load_dwordx4 v17, s[16:19], s53 offen offset:1024 lds
    s_mov_b32 s5, s4
    s_mul_i32 s44, s5, 28672
    s_add_u32 s5, s5, 1
    s_cmp_eq_u32 s5, 7
    s_cselect_b32 s5, 0, s5
    s_mul_i32 s45, s5, 28672
    s_add_u32 s5, s5, 1
    s_cmp_eq_u32 s5, 7
    s_cselect_b32 s5, 0, s5
    s_mul_i32 s46, s5, 28672
    s_add_u32 s5, s5, 1
    s_cmp_eq_u32 s5, 7
    s_cselect_b32 s5, 0, s5
    s_mul_i32 s47, s5, 28672
    s_add_u32 s5, s5, 1
    s_cmp_eq_u32 s5, 7
    s_cselect_b32 s5, 0, s5
    s_mul_i32 s48, s5, 28672
    s_add_u32 s5, s5, 1
    s_cmp_eq_u32 s5, 7
    s_cselect_b32 s5, 0, s5
    s_mul_i32 s49, s5, 28672
    s_add_u32 s5, s5, 1
    s_cmp_eq_u32 s5, 7
    s_cselect_b32 s5, 0, s5
    s_mul_i32 s50, s5, 28672
    v_add_u32 v20, 802816, v26
    v_add_u32 v21, 802816, v27
    v_add_u32 v22, 802816, v28
    v_add_u32 v23, 802816, v29
    s_waitcnt vmcnt(6)
    s_barrier
    s_add_u32 m0, s66, 0x20000
    s_nop 0
    buffer_load_dwordx4 v16, s[12:15], s54 offen offset:0 lds
    buffer_load_dwordx4 v16, s[16:19], s54 offen offset:1024 lds
    s_waitcnt vmcnt(6)
    s_barrier
    s_add_u32 m0, s66, 0x22000
    s_nop 0
    buffer_load_dwordx4 v17, s[12:15], s54 offen offset:0 lds
    buffer_load_dwordx4 v17, s[16:19], s54 offen offset:1024 lds
    s_add_u32 m0, s62, 0x0
    s_nop 0
    buffer_load_dwordx4 v26, s[32:35], s44 offen offset:0 lds
    buffer_load_dwordx4 v27, s[32:35], s44 offen offset:1024 lds
    buffer_load_dwordx4 v28, s[32:35], s44 offen offset:2048 lds
    buffer_load_dwordx4 v29, s[32:35], s44 offen offset:3072 lds
    s_waitcnt vmcnt(10)
    s_barrier
    s_add_u32 m0, s66, 0x24000
    s_nop 0
    buffer_load_dwordx4 v16, s[12:15], s55 offen offset:0 lds
    buffer_load_dwordx4 v16, s[16:19], s55 offen offset:1024 lds
    s_waitcnt vmcnt(10)
    s_barrier
    s_add_u32 m0, s66, 0x26000
    s_nop 0
    buffer_load_dwordx4 v17, s[12:15], s55 offen offset:0 lds
    buffer_load_dwordx4 v17, s[16:19], s55 offen offset:1024 lds
    s_add_u32 m0, s62, 0x4000
    s_nop 0
    buffer_load_dwordx4 v26, s[32:35], s45 offen offset:0 lds
    buffer_load_dwordx4 v27, s[32:35], s45 offen offset:1024 lds
    buffer_load_dwordx4 v28, s[32:35], s45 offen offset:2048 lds
    buffer_load_dwordx4 v29, s[32:35], s45 offen offset:3072 lds
    s_waitcnt vmcnt(14)
    s_barrier
    s_add_u32 m0, s66, 0x1c000
    s_nop 0
    buffer_load_dwordx4 v16, s[12:15], s56 offen offset:0 lds
    buffer_load_dwordx4 v16, s[16:19], s56 offen offset:1024 lds
    s_waitcnt vmcnt(14)
    s_barrier
    s_add_u32 m0, s66, 0x1e000
    s_nop 0
    buffer_load_dwordx4 v17, s[12:15], s56 offen offset:0 lds
    buffer_load_dwordx4 v17, s[16:19], s56 offen offset:1024 lds
    s_add_u32 m0, s62, 0x8000
    s_nop 0
    buffer_load_dwordx4 v26, s[32:35], s46 offen offset:0 lds
    buffer_load_dwordx4 v27, s[32:35], s46 offen offset:1024 lds
    buffer_load_dwordx4 v28, s[32:35], s46 offen offset:2048 lds
    buffer_load_dwordx4 v29, s[32:35], s46 offen offset:3072 lds
    s_waitcnt vmcnt(14)
    s_barrier
    s_add_u32 m0, s66, 0x20000
    s_nop 0
    buffer_load_dwordx4 v16, s[12:15], s57 offen offset:0 lds
    buffer_load_dwordx4 v16, s[16:19], s57 offen offset:1024 lds
    s_waitcnt vmcnt(14)
    s_barrier
    s_add_u32 m0, s66, 0x22000
    s_nop 0
    buffer_load_dwordx4 v17, s[12:15], s57 offen offset:0 lds
    buffer_load_dwordx4 v17, s[16:19], s57 offen offset:1024 lds
    s_add_u32 m0, s62, 0xc000
    s_nop 0
    buffer_load_dwordx4 v26, s[32:35], s47 offen offset:0 lds
    buffer_load_dwordx4 v27, s[32:35], s47 offen offset:1024 lds
    buffer_load_dwordx4 v28, s[32:35], s47 offen offset:2048 lds
    buffer_load_dwordx4 v29, s[32:35], s47 offen offset:3072 lds
    s_cmp_lg_u32 s40, 4
    s_cbranch_scc1 FA_4
    v_mov_b32 v60, s98
    v_lshlrev_b32 v61, 24, v1
    v_add_u32 v61, s99, v61
    buffer_store_dword v60, v61, s[20:23], 0 offen sc1
FA_4:
    s_waitcnt vmcnt(14)
    s_barrier
    s_waitcnt vmcnt(12)
    s_barrier
    s_add_u32 m0, s62, 0x10000
    s_nop 0
    buffer_load_dwordx4 v26, s[32:35], s48 offen offset:0 lds
    buffer_load_dwordx4 v27, s[32:35], s48 offen offset:1024 lds
    buffer_load_dwordx4 v28, s[32:35], s48 offen offset:2048 lds
    buffer_load_dwordx4 v29, s[32:35], s48 offen offset:3072 lds
    s_waitcnt vmcnt(10)
    s_barrier
    s_waitcnt vmcnt(8)
    s_barrier
    s_add_u32 m0, s62, 0x14000
    s_nop 0
    buffer_load_dwordx4 v26, s[32:35], s49 offen offset:0 lds
    buffer_load_dwordx4 v27, s[32:35], s49 offen offset:1024 lds
    buffer_load_dwordx4 v28, s[32:35], s49 offen offset:2048 lds
    buffer_load_dwordx4 v29, s[32:35], s49 offen offset:3072 lds
    s_lshr_b32 s43, s70, 1
    s_lshl_b32 s43, s43, 9
    s_add_u32 s100, s43, 0x910000
    v_lshlrev_b32 v61, 2, v1
    v_add_u32 v61, s100, v61
    v_cmp_gt_u32 vcc, 14, v1
    v_mov_b32 v60, 0x7fffffff
    s_nop 0
    v_cndmask_b32 v61, v60, v61, vcc
    buffer_load_dword v60, v61, s[20:23], 0 offen sc1
    s_barrier
    v_and_b32 v2, 15, v1
    v_lshrrev_b32 v3, 2, v2
    v_lshrrev_b32 v8, 5, v1
    v_lshlrev_b32 v5, 2, v8
    v_add_u32 v5, v5, v3
    v_lshlrev_b32 v5, 7, v5
    v_bfe_u32 v6, v2, 3, 1
    v_lshlrev_b32 v6, 6, v6
    v_bfe_u32 v3, v1, 4, 1
    v_lshlrev_b32 v3, 5, v3
    v_and_b32 v8, 3, v2
    v_lshlrev_b32 v8, 3, v8
    v_add3_u32 v5, v5, v6, v3
    v_add_u32 v5, v5, v8
    v_add_u32 v11, s62, v5
    v_xor_b32 v12, 64, v11
    v_add_u32 v18, 0x10000, v11
    v_add_u32 v19, 0x10000, v12
    v_add_u32 v15, 0x20000, v11
    v_add_u32 v63, 0x20000, v12
    s_mul_i32 s41, s70, 112
    s_mul_i32 s42, s3, 14
    s_add_u32 s41, s41, s42
    s_lshl_b32 s41, s41, 11
    v_lshlrev_b32 v13, 4, v1
    v_add_u32 v13, s41, v13
    v_and_b32 v14, 31, v1
    s_mov_b32 s5, s4
    s_mul_i32 s51, s5, 4096
    s_add_u32 s5, s5, 1
    s_cmp_eq_u32 s5, 7
    s_cselect_b32 s5, 0, s5
    s_mul_i32 s52, s5, 4096
    s_add_u32 s5, s5, 1
    s_cmp_eq_u32 s5, 7
    s_cselect_b32 s5, 0, s5
    s_mul_i32 s53, s5, 4096
    s_add_u32 s5, s5, 1
    s_cmp_eq_u32 s5, 7
    s_cselect_b32 s5, 0, s5
    s_mul_i32 s54, s5, 4096
    s_add_u32 s5, s5, 1
    s_cmp_eq_u32 s5, 7
    s_cselect_b32 s5, 0, s5
    s_mul_i32 s55, s5, 4096
    s_add_u32 s5, s5, 1
    s_cmp_eq_u32 s5, 7
    s_cselect_b32 s5, 0, s5
    s_mul_i32 s56, s5, 4096
    s_add_u32 s5, s5, 1
    s_cmp_eq_u32 s5, 7
    s_cselect_b32 s5, 0, s5
    s_mul_i32 s57, s5, 4096
    s_waitcnt vmcnt(1)
    s_waitcnt lgkmcnt(0)
    s_barrier
    s_mov_b32 s41, 0
    s_branch POLLC_7
POLL_5:
    buffer_load_dword v60, v61, s[20:23], 0 offen sc1
POLLC_7:
    s_waitcnt vmcnt(0)
    v_cmp_eq_u32 vcc, s98, v60
    s_nop 1
    s_and_b32 s42, vcc_lo, 0x3fff
    s_cmp_eq_u32 s42, 0x3fff
    s_cbranch_scc1 POLLD_6
    s_add_u32 s41, s41, 1
    s_cmp_ge_u32 s41, 0x40000
    s_cbranch_scc1 POLLD_6
    s_branch POLL_5
POLLD_6:
    buffer_load_dwordx4 v[128:131], v13, s[20:23], s51 offen offset:0 sc1
    buffer_load_dwordx4 v[132:135], v13, s[20:23], s51 offen offset:1024 sc1
    buffer_load_dwordx4 v[136:139], v13, s[20:23], s51 offen offset:2048 sc1
    buffer_load_dwordx4 v[140:143], v13, s[20:23], s51 offen offset:3072 sc1
    buffer_load_dwordx4 v[144:147], v13, s[20:23], s52 offen offset:0 sc1
    buffer_load_dwordx4 v[148:151], v13, s[20:23], s52 offen offset:1024 sc1
    buffer_load_dwordx4 v[152:155], v13, s[20:23], s52 offen offset:2048 sc1
    buffer_load_dwordx4 v[156:159], v13, s[20:23], s52 offen offset:3072 sc1
    buffer_load_dwordx4 v[160:163], v13, s[20:23], s53 offen offset:0 sc1
    buffer_load_dwordx4 v[164:167], v13, s[20:23], s53 offen offset:1024 sc1
    s_add_u32 m0, s62, 0x18000
    s_nop 0
    buffer_load_dwordx4 v26, s[32:35], s50 offen offset:0 lds
    buffer_load_dwordx4 v27, s[32:35], s50 offen offset:1024 lds
    buffer_load_dwordx4 v28, s[32:35], s50 offen offset:2048 lds
    buffer_load_dwordx4 v29, s[32:35], s50 offen offset:3072 lds
    ds_read_b64_tr_b16 v[240:241], v11 offset:0
    ds_read_b64_tr_b16 v[242:243], v11 offset:1024
    ds_read_b64_tr_b16 v[244:245], v12 offset:0
    ds_read_b64_tr_b16 v[246:247], v12 offset:1024
    buffer_load_dwordx4 v[168:171], v13, s[20:23], s53 offen offset:2048 sc1
    buffer_load_dwordx4 v[172:175], v13, s[20:23], s53 offen offset:3072 sc1
    ds_read_b64_tr_b16 v[248:249], v11 offset:2048
    ds_read_b64_tr_b16 v[250:251], v11 offset:3072
    ds_read_b64_tr_b16 v[252:253], v12 offset:2048
    ds_read_b64_tr_b16 v[254:255], v12 offset:3072
    s_waitcnt vmcnt(14)
    s_waitcnt lgkmcnt(6)
    v_mfma_f32_32x32x16_bf16 v[64:79], v[240:243], v[128:131], 0
    v_mfma_f32_32x32x16_bf16 v[80:95], v[240:243], v[132:135], 0
    s_waitcnt lgkmcnt(4)
    v_mfma_f32_32x32x16_bf16 v[96:111], v[244:247], v[128:131], 0
    v_mfma_f32_32x32x16_bf16 v[112:127], v[244:247], v[132:135], 0
    buffer_load_dwordx4 v[176:179], v13, s[20:23], s57 offen offset:0 sc1
    buffer_load_dwordx4 v[180:183], v13, s[20:23], s57 offen offset:1024 sc1
    ds_read_b64_tr_b16 v[240:241], v11 offset:16384
    ds_read_b64_tr_b16 v[242:243], v11 offset:17408
    ds_read_b64_tr_b16 v[244:245], v12 offset:16384
    ds_read_b64_tr_b16 v[246:247], v12 offset:17408
    s_waitcnt vmcnt(14)
    s_waitcnt lgkmcnt(6)
    v_mfma_f32_32x32x16_bf16 v[64:79], v[248:251], v[136:139], v[64:79]
    v_mfma_f32_32x32x16_bf16 v[80:95], v[248:251], v[140:143], v[80:95]
    s_waitcnt lgkmcnt(4)
    v_mfma_f32_32x32x16_bf16 v[96:111], v[252:255], v[136:139], v[96:111]
    v_mfma_f32_32x32x16_bf16 v[112:127], v[252:255], v[140:143], v[112:127]
    s_add_u32 m0, s62, 0x0
    s_nop 0
    buffer_load_dwordx4 v20, s[32:35], s50 offen offset:0 lds
    buffer_load_dwordx4 v21, s[32:35], s50 offen offset:1024 lds
    buffer_load_dwordx4 v22, s[32:35], s50 offen offset:2048 lds
    buffer_load_dwordx4 v23, s[32:35], s50 offen offset:3072 lds
    buffer_load_dwordx4 v[184:187], v13, s[20:23], s57 offen offset:2048 sc1
    buffer_load_dwordx4 v[188:191], v13, s[20:23], s57 offen offset:3072 sc1
    ds_read_b64_tr_b16 v[248:249], v11 offset:18432
    ds_read_b64_tr_b16 v[250:251], v11 offset:19456
    ds_read_b64_tr_b16 v[252:253], v12 offset:18432
    ds_read_b64_tr_b16 v[254:255], v12 offset:19456
    s_waitcnt vmcnt(18)
    s_waitcnt lgkmcnt(6)
    v_mfma_f32_32x32x16_bf16 v[64:79], v[240:243], v[144:147], v[64:79]
    v_mfma_f32_32x32x16_bf16 v[80:95], v[240:243], v[148:151], v[80:95]
    s_waitcnt lgkmcnt(4)
    v_mfma_f32_32x32x16_bf16 v[96:111], v[244:247], v[144:147], v[96:111]
    v_mfma_f32_32x32x16_bf16 v[112:127], v[244:247], v[148:151], v[112:127]
    ds_read_b64_tr_b16 v[240:241], v11 offset:32768
    ds_read_b64_tr_b16 v[242:243], v11 offset:33792
    ds_read_b64_tr_b16 v[244:245], v12 offset:32768
    ds_read_b64_tr_b16 v[246:247], v12 offset:33792
    s_waitcnt vmcnt(16)
    s_waitcnt lgkmcnt(6)
    v_mfma_f32_32x32x16_bf16 v[64:79], v[248:251], v[152:155], v[64:79]
    v_mfma_f32_32x32x16_bf16 v[80:95], v[248:251], v[156:159], v[80:95]
    s_waitcnt lgkmcnt(4)
    v_mfma_f32_32x32x16_bf16 v[96:111], v[252:255], v[152:155], v[96:111]
    v_mfma_f32_32x32x16_bf16 v[112:127], v[252:255], v[156:159], v[112:127]
    ds_read_b64_tr_b16 v[248:249], v11 offset:34816
    ds_read_b64_tr_b16 v[250:251], v11 offset:35840
    ds_read_b64_tr_b16 v[252:253], v12 offset:34816
    ds_read_b64_tr_b16 v[254:255], v12 offset:35840
    s_waitcnt vmcnt(14)
    s_waitcnt lgkmcnt(6)
    v_mfma_f32_32x32x16_bf16 v[64:79], v[240:243], v[160:163], v[64:79]
    v_mfma_f32_32x32x16_bf16 v[80:95], v[240:243], v[164:167], v[80:95]
    s_waitcnt lgkmcnt(4)
    v_mfma_f32_32x32x16_bf16 v[96:111], v[244:247], v[160:163], v[96:111]
    v_mfma_f32_32x32x16_bf16 v[112:127], v[244:247], v[164:167], v[112:127]
    s_waitcnt vmcnt(12)
    ds_read_b64_tr_b16 v[240:241], v18 offset:32768
    ds_read_b64_tr_b16 v[242:243], v18 offset:33792
    ds_read_b64_tr_b16 v[244:245], v19 offset:32768
    ds_read_b64_tr_b16 v[246:247], v19 offset:33792
    s_waitcnt vmcnt(8)
    s_waitcnt lgkmcnt(6)
    v_mfma_f32_32x32x16_bf16 v[64:79], v[248:251], v[168:171], v[64:79]
    v_mfma_f32_32x32x16_bf16 v[80:95], v[248:251], v[172:175], v[80:95]
    s_waitcnt lgkmcnt(4)
    v_mfma_f32_32x32x16_bf16 v[96:111], v[252:255], v[168:171], v[96:111]
    v_mfma_f32_32x32x16_bf16 v[112:127], v[252:255], v[172:175], v[112:127]
    ds_read_b64_tr_b16 v[248:249], v18 offset:34816
    ds_read_b64_tr_b16 v[250:251], v18 offset:35840
    ds_read_b64_tr_b16 v[252:253], v19 offset:34816
    ds_read_b64_tr_b16 v[254:255], v19 offset:35840
    s_waitcnt vmcnt(6)
    s_waitcnt lgkmcnt(6)
    v_mfma_f32_32x32x16_bf16 v[64:79], v[240:243], v[176:179], v[64:79]
    v_mfma_f32_32x32x16_bf16 v[80:95], v[240:243], v[180:183], v[80:95]
    s_waitcnt lgkmcnt(4)
    v_mfma_f32_32x32x16_bf16 v[96:111], v[244:247], v[176:179], v[96:111]
    v_mfma_f32_32x32x16_bf16 v[112:127], v[244:247], v[180:183], v[112:127]
    s_waitcnt vmcnt(0)
    s_waitcnt lgkmcnt(2)
    v_mfma_f32_32x32x16_bf16 v[64:79], v[248:251], v[184:187], v[64:79]
    v_mfma_f32_32x32x16_bf16 v[80:95], v[248:251], v[188:191], v[80:95]
    s_waitcnt lgkmcnt(0)
    v_mfma_f32_32x32x16_bf16 v[96:111], v[252:255], v[184:187], v[96:111]
    v_mfma_f32_32x32x16_bf16 v[112:127], v[252:255], v[188:191], v[112:127]
    v_lshlrev_b32 v2, 4, v1
    v_add_u32 v2, s62, v2
    v_add_u32 v3, 0x10000, v2
    s_nop 7
    s_nop 3
    ds_write_b128 v2, v[64:67] offset:16384
    ds_write_b128 v2, v[68:71] offset:17408
    ds_write_b128 v2, v[72:75] offset:18432
    ds_write_b128 v2, v[76:79] offset:19456
    ds_write_b128 v2, v[80:83] offset:32768
    ds_write_b128 v2, v[84:87] offset:33792
    ds_write_b128 v2, v[88:91] offset:34816
    ds_write_b128 v2, v[92:95] offset:35840
    ds_write_b128 v3, v[96:99] offset:32768
    ds_write_b128 v3, v[100:103] offset:33792
    ds_write_b128 v3, v[104:107] offset:34816
    ds_write_b128 v3, v[108:111] offset:35840
    s_waitcnt vmcnt(0) lgkmcnt(0)
    s_barrier
    v_add_u32 v3, 0x1c000, v2
    ds_write_b128 v3, v[112:115] offset:0
    ds_write_b128 v3, v[116:119] offset:1024
    ds_write_b128 v3, v[120:123] offset:2048
    ds_write_b128 v3, v[124:127] offset:3072
    s_waitcnt lgkmcnt(0)
    s_barrier
    s_endpgm
P1_H_CONSUMER:
    s_setprio 1
    s_lshr_b32 s69, s40, 1
    s_and_b32 s64, s40, 1
    v_and_b32 v26, 31, v1
    v_lshrrev_b32 v27, 5, v1
    v_lshrrev_b32 v28, 1, v26
    v_and_b32 v28, 7, v28
    s_lshl_b32 s41, s69, 6
    v_add_u32 v29, s41, v26
    v_lshlrev_b32 v29, 7, v29
    v_add_u32 v30, 0, v27
    v_xor_b32 v30, v30, v28
    v_lshlrev_b32 v30, 4, v30
    v_add_u32 v10, v29, v30
    v_add_u32 v14, 0x10000, v10
    v_add_u32 v30, 2, v27
    v_xor_b32 v30, v30, v28
    v_lshlrev_b32 v30, 4, v30
    v_add_u32 v11, v29, v30
    v_add_u32 v15, 0x10000, v11
    v_add_u32 v30, 4, v27
    v_xor_b32 v30, v30, v28
    v_lshlrev_b32 v30, 4, v30
    v_add_u32 v12, v29, v30
    v_add_u32 v16, 0x10000, v12
    v_add_u32 v30, 6, v27
    v_xor_b32 v30, v30, v28
    v_lshlrev_b32 v30, 4, v30
    v_add_u32 v13, v29, v30
    v_add_u32 v17, 0x10000, v13
    v_and_b32 v30, 15, v1
    v_lshrrev_b32 v31, 2, v30
    v_lshlrev_b32 v31, 7, v31
    v_lshlrev_b32 v32, 11, v27
    v_add_u32 v32, v32, v31
    v_bfe_u32 v33, v30, 3, 1
    v_xor_b32 v33, s64, v33
    v_lshlrev_b32 v33, 6, v33
    v_add_u32 v32, v32, v33
    v_bfe_u32 v33, v1, 4, 1
    v_lshlrev_b32 v33, 5, v33
    v_add_u32 v32, v32, v33
    v_and_b32 v33, 3, v30
    v_lshlrev_b32 v33, 3, v33
    v_add_u32 v32, v32, v33
    v_add_u32 v18, 0x1c000, v32
    s_waitcnt lgkmcnt(0)
    s_mov_b32 s20, s74
    s_and_b32 s21, s75, 0xffff
    s_mov_b32 s22, 0x1000000
    s_mov_b32 s23, 0x20000
    s_or_b32 s41, s2, s40
    s_cmp_lg_u32 s41, 0
    s_cbranch_scc1 NONCE_8
    s_mov_b32 s36, s72
    s_and_b32 s37, s73, 0xffff
    s_mov_b32 s38, 0x100
    s_mov_b32 s39, 0x20000
    s_memrealtime s[42:43]
    s_waitcnt lgkmcnt(0)
    s_or_b32 s42, s42, 1
    v_mov_b32 v4, s42
    v_lshlrev_b32 v5, 20, v1
    buffer_store_dword v4, v5, s[36:39], 0 offen sc1
NONCE_8:
    s_barrier
    ds_read_b64_tr_b16 v[200:201], v18 offset:0
    ds_read_b64_tr_b16 v[202:203], v18 offset:512
    ds_read_b128 v[192:195], v10 offset:0
    ds_read_b64_tr_b16 v[204:205], v18 offset:1024
    ds_read_b64_tr_b16 v[206:207], v18 offset:1536
    ds_read_b128 v[196:199], v10 offset:4096
    s_waitcnt lgkmcnt(3)
    v_mfma_f32_32x32x16_bf16 v[64:79], v[200:203], v[192:195], 0
    ds_read_b64_tr_b16 v[216:217], v18 offset:4096
    ds_read_b64_tr_b16 v[218:219], v18 offset:4608
    s_lshl_b32 s41, s60, 1
    s_add_u32 s41, s41, s69
    s_mul_i32 s41, s41, 112
    s_waitcnt lgkmcnt(3)
    v_mfma_f32_32x32x16_bf16 v[96:111], v[204:207], v[192:195], 0
    ds_read_b128 v[208:211], v11 offset:0
    ds_read_b64_tr_b16 v[220:221], v18 offset:5120
    s_lshl_b32 s42, s61, 1
    s_add_u32 s42, s42, s64
    s_lshl_b32 s42, s42, 1
    s_waitcnt lgkmcnt(4)
    v_mfma_f32_32x32x16_bf16 v[80:95], v[200:203], v[196:199], 0
    ds_read_b64_tr_b16 v[222:223], v18 offset:5632
    s_add_u32 s41, s41, s42
    s_lshl_b32 s41, s41, 11
    v_lshlrev_b32 v20, 4, v1
    v_mfma_f32_32x32x16_bf16 v[112:127], v[204:207], v[196:199], 0
    ds_read_b128 v[212:215], v11 offset:4096
    v_add_u32 v20, s41, v20
    v_add_u32 v21, 0x1c000, v20
    s_lshl_b32 s41, s60, 9
    s_waitcnt lgkmcnt(3)
    v_mfma_f32_32x32x16_bf16 v[64:79], v[216:219], v[208:211], v[64:79]
    ds_read_b64_tr_b16 v[200:201], v18 offset:8192
    ds_read_b64_tr_b16 v[202:203], v18 offset:8704
    s_lshl_b32 s42, s61, 2
    s_add_u32 s41, s41, s42
    s_add_u32 s99, s41, 0x910000
    s_waitcnt lgkmcnt(3)
    v_mfma_f32_32x32x16_bf16 v[96:111], v[220:223], v[208:211], v[96:111]
    ds_read_b128 v[192:195], v12 offset:0
    ds_read_b64_tr_b16 v[204:205], v18 offset:9216
    s_mov_b32 s36, s72
    s_and_b32 s37, s73, 0xffff
    s_mov_b32 s38, 0x100
    s_waitcnt lgkmcnt(4)
    v_mfma_f32_32x32x16_bf16 v[80:95], v[216:219], v[212:215], v[80:95]
    ds_read_b64_tr_b16 v[206:207], v18 offset:9728
    s_mov_b32 s39, 0x20000
    v_mov_b32 v7, 0
    s_mov_b32 s44, 0xbfb8aa3b
    v_mfma_f32_32x32x16_bf16 v[112:127], v[220:223], v[212:215], v[112:127]
    ds_read_b128 v[196:199], v12 offset:4096
    s_mov_b32 s45, s44
    s_barrier
    s_waitcnt lgkmcnt(3)
    v_mfma_f32_32x32x16_bf16 v[64:79], v[200:203], v[192:195], v[64:79]
    ds_read_b64_tr_b16 v[216:217], v18 offset:12288
    ds_read_b64_tr_b16 v[218:219], v18 offset:12800
    s_waitcnt lgkmcnt(3)
    v_mfma_f32_32x32x16_bf16 v[96:111], v[204:207], v[192:195], v[96:111]
    ds_read_b128 v[208:211], v13 offset:0
    ds_read_b64_tr_b16 v[220:221], v18 offset:13312
    s_waitcnt lgkmcnt(4)
    v_mfma_f32_32x32x16_bf16 v[80:95], v[200:203], v[196:199], v[80:95]
    ds_read_b64_tr_b16 v[222:223], v18 offset:13824
    v_mfma_f32_32x32x16_bf16 v[112:127], v[204:207], v[196:199], v[112:127]
    ds_read_b128 v[212:215], v13 offset:4096
    s_waitcnt lgkmcnt(3)
    v_mfma_f32_32x32x16_bf16 v[64:79], v[216:219], v[208:211], v[64:79]
    ds_read_b64_tr_b16 v[200:201], v18 offset:16384
    ds_read_b64_tr_b16 v[202:203], v18 offset:16896
    s_waitcnt lgkmcnt(3)
    v_mfma_f32_32x32x16_bf16 v[96:111], v[220:223], v[208:211], v[96:111]
    ds_read_b128 v[192:195], v10 offset:16384
    ds_read_b64_tr_b16 v[204:205], v18 offset:17408
    s_waitcnt lgkmcnt(4)
    v_mfma_f32_32x32x16_bf16 v[80:95], v[216:219], v[212:215], v[80:95]
    ds_read_b64_tr_b16 v[206:207], v18 offset:17920
    v_mfma_f32_32x32x16_bf16 v[112:127], v[220:223], v[212:215], v[112:127]
    ds_read_b128 v[196:199], v10 offset:20480
    s_barrier
    s_waitcnt lgkmcnt(3)
    v_mfma_f32_32x32x16_bf16 v[64:79], v[200:203], v[192:195], v[64:79]
    ds_read_b64_tr_b16 v[216:217], v18 offset:20480
    ds_read_b64_tr_b16 v[218:219], v18 offset:20992
    s_waitcnt lgkmcnt(3)
    v_mfma_f32_32x32x16_bf16 v[96:111], v[204:207], v[192:195], v[96:111]
    ds_read_b128 v[208:211], v11 offset:16384
    ds_read_b64_tr_b16 v[220:221], v18 offset:21504
    s_waitcnt lgkmcnt(4)
    v_mfma_f32_32x32x16_bf16 v[80:95], v[200:203], v[196:199], v[80:95]
    ds_read_b64_tr_b16 v[222:223], v18 offset:22016
    v_mfma_f32_32x32x16_bf16 v[112:127], v[204:207], v[196:199], v[112:127]
    ds_read_b128 v[212:215], v11 offset:20480
    s_waitcnt lgkmcnt(3)
    v_mfma_f32_32x32x16_bf16 v[64:79], v[216:219], v[208:211], v[64:79]
    ds_read_b64_tr_b16 v[200:201], v18 offset:24576
    ds_read_b64_tr_b16 v[202:203], v18 offset:25088
    s_waitcnt lgkmcnt(3)
    v_mfma_f32_32x32x16_bf16 v[96:111], v[220:223], v[208:211], v[96:111]
    ds_read_b128 v[192:195], v12 offset:16384
    ds_read_b64_tr_b16 v[204:205], v18 offset:25600
    s_waitcnt lgkmcnt(4)
    v_mfma_f32_32x32x16_bf16 v[80:95], v[216:219], v[212:215], v[80:95]
    ds_read_b64_tr_b16 v[206:207], v18 offset:26112
    v_mfma_f32_32x32x16_bf16 v[112:127], v[220:223], v[212:215], v[112:127]
    ds_read_b128 v[196:199], v12 offset:20480
    s_barrier
    s_waitcnt lgkmcnt(3)
    v_mfma_f32_32x32x16_bf16 v[64:79], v[200:203], v[192:195], v[64:79]
    ds_read_b64_tr_b16 v[216:217], v18 offset:28672
    ds_read_b64_tr_b16 v[218:219], v18 offset:29184
    s_waitcnt lgkmcnt(3)
    v_mfma_f32_32x32x16_bf16 v[96:111], v[204:207], v[192:195], v[96:111]
    ds_read_b128 v[208:211], v13 offset:16384
    ds_read_b64_tr_b16 v[220:221], v18 offset:29696
    s_waitcnt lgkmcnt(4)
    v_mfma_f32_32x32x16_bf16 v[80:95], v[200:203], v[196:199], v[80:95]
    ds_read_b64_tr_b16 v[222:223], v18 offset:30208
    v_mfma_f32_32x32x16_bf16 v[112:127], v[204:207], v[196:199], v[112:127]
    ds_read_b128 v[212:215], v13 offset:20480
    s_waitcnt lgkmcnt(3)
    v_mfma_f32_32x32x16_bf16 v[64:79], v[216:219], v[208:211], v[64:79]
    ds_read_b64_tr_b16 v[200:201], v18 offset:32768
    ds_read_b64_tr_b16 v[202:203], v18 offset:33280
    s_waitcnt lgkmcnt(3)
    v_mfma_f32_32x32x16_bf16 v[96:111], v[220:223], v[208:211], v[96:111]
    ds_read_b128 v[192:195], v10 offset:32768
    ds_read_b64_tr_b16 v[204:205], v18 offset:33792
    s_waitcnt lgkmcnt(4)
    v_mfma_f32_32x32x16_bf16 v[80:95], v[216:219], v[212:215], v[80:95]
    ds_read_b64_tr_b16 v[206:207], v18 offset:34304
    v_mfma_f32_32x32x16_bf16 v[112:127], v[220:223], v[212:215], v[112:127]
    ds_read_b128 v[196:199], v10 offset:36864
    s_barrier
    s_waitcnt lgkmcnt(3)
    v_mfma_f32_32x32x16_bf16 v[64:79], v[200:203], v[192:195], v[64:79]
    ds_read_b64_tr_b16 v[216:217], v18 offset:36864
    ds_read_b64_tr_b16 v[218:219], v18 offset:37376
    s_waitcnt lgkmcnt(3)
    v_mfma_f32_32x32x16_bf16 v[96:111], v[204:207], v[192:195], v[96:111]
    ds_read_b128 v[208:211], v11 offset:32768
    ds_read_b64_tr_b16 v[220:221], v18 offset:37888
    s_waitcnt lgkmcnt(4)
    v_mfma_f32_32x32x16_bf16 v[80:95], v[200:203], v[196:199], v[80:95]
    ds_read_b64_tr_b16 v[222:223], v18 offset:38400
    v_mfma_f32_32x32x16_bf16 v[112:127], v[204:207], v[196:199], v[112:127]
    ds_read_b128 v[212:215], v11 offset:36864
    s_waitcnt lgkmcnt(3)
    v_mfma_f32_32x32x16_bf16 v[64:79], v[216:219], v[208:211], v[64:79]
    ds_read_b64_tr_b16 v[200:201], v18 offset:40960
    ds_read_b64_tr_b16 v[202:203], v18 offset:41472
    s_waitcnt lgkmcnt(3)
    v_mfma_f32_32x32x16_bf16 v[96:111], v[220:223], v[208:211], v[96:111]
    ds_read_b128 v[192:195], v12 offset:32768
    ds_read_b64_tr_b16 v[204:205], v18 offset:41984
    s_waitcnt lgkmcnt(4)
    v_mfma_f32_32x32x16_bf16 v[80:95], v[216:219], v[212:215], v[80:95]
    ds_read_b64_tr_b16 v[206:207], v18 offset:42496
    v_mfma_f32_32x32x16_bf16 v[112:127], v[220:223], v[212:215], v[112:127]
    ds_read_b128 v[196:199], v12 offset:36864
    s_barrier
    s_waitcnt lgkmcnt(3)
    v_mfma_f32_32x32x16_bf16 v[64:79], v[200:203], v[192:195], v[64:79]
    ds_read_b64_tr_b16 v[216:217], v18 offset:45056
    ds_read_b64_tr_b16 v[218:219], v18 offset:45568
    s_waitcnt lgkmcnt(3)
    v_mfma_f32_32x32x16_bf16 v[96:111], v[204:207], v[192:195], v[96:111]
    ds_read_b128 v[208:211], v13 offset:32768
    ds_read_b64_tr_b16 v[220:221], v18 offset:46080
    s_waitcnt lgkmcnt(4)
    v_mfma_f32_32x32x16_bf16 v[80:95], v[200:203], v[196:199], v[80:95]
    ds_read_b64_tr_b16 v[222:223], v18 offset:46592
    v_mfma_f32_32x32x16_bf16 v[112:127], v[204:207], v[196:199], v[112:127]
    ds_read_b128 v[212:215], v13 offset:36864
    s_waitcnt lgkmcnt(3)
    v_mfma_f32_32x32x16_bf16 v[64:79], v[216:219], v[208:211], v[64:79]
    ds_read_b64_tr_b16 v[200:201], v18 offset:0
    ds_read_b64_tr_b16 v[202:203], v18 offset:512
    s_waitcnt lgkmcnt(3)
    v_mfma_f32_32x32x16_bf16 v[96:111], v[220:223], v[208:211], v[96:111]
    ds_read_b128 v[192:195], v10 offset:49152
    ds_read_b64_tr_b16 v[204:205], v18 offset:1024
    s_waitcnt lgkmcnt(4)
    v_mfma_f32_32x32x16_bf16 v[80:95], v[216:219], v[212:215], v[80:95]
    ds_read_b64_tr_b16 v[206:207], v18 offset:1536
    v_mfma_f32_32x32x16_bf16 v[112:127], v[220:223], v[212:215], v[112:127]
    ds_read_b128 v[196:199], v10 offset:53248
    s_barrier
    s_waitcnt lgkmcnt(3)
    v_mfma_f32_32x32x16_bf16 v[64:79], v[200:203], v[192:195], v[64:79]
    ds_read_b64_tr_b16 v[216:217], v18 offset:4096
    ds_read_b64_tr_b16 v[218:219], v18 offset:4608
    s_waitcnt lgkmcnt(3)
    v_mfma_f32_32x32x16_bf16 v[96:111], v[204:207], v[192:195], v[96:111]
    ds_read_b128 v[208:211], v11 offset:49152
    ds_read_b64_tr_b16 v[220:221], v18 offset:5120
    s_waitcnt lgkmcnt(4)
    v_mfma_f32_32x32x16_bf16 v[80:95], v[200:203], v[196:199], v[80:95]
    ds_read_b64_tr_b16 v[222:223], v18 offset:5632
    v_mfma_f32_32x32x16_bf16 v[112:127], v[204:207], v[196:199], v[112:127]
    ds_read_b128 v[212:215], v11 offset:53248
    s_waitcnt lgkmcnt(3)
    v_mfma_f32_32x32x16_bf16 v[64:79], v[216:219], v[208:211], v[64:79]
    ds_read_b64_tr_b16 v[200:201], v18 offset:8192
    ds_read_b64_tr_b16 v[202:203], v18 offset:8704
    s_waitcnt lgkmcnt(3)
    v_mfma_f32_32x32x16_bf16 v[96:111], v[220:223], v[208:211], v[96:111]
    ds_read_b128 v[192:195], v12 offset:49152
    ds_read_b64_tr_b16 v[204:205], v18 offset:9216
    s_waitcnt lgkmcnt(4)
    v_mfma_f32_32x32x16_bf16 v[80:95], v[216:219], v[212:215], v[80:95]
    ds_read_b64_tr_b16 v[206:207], v18 offset:9728
    v_mfma_f32_32x32x16_bf16 v[112:127], v[220:223], v[212:215], v[112:127]
    ds_read_b128 v[196:199], v12 offset:53248
    s_barrier
    s_waitcnt lgkmcnt(3)
    v_mfma_f32_32x32x16_bf16 v[64:79], v[200:203], v[192:195], v[64:79]
    ds_read_b64_tr_b16 v[216:217], v18 offset:12288
    ds_read_b64_tr_b16 v[218:219], v18 offset:12800
    s_waitcnt lgkmcnt(3)
    v_mfma_f32_32x32x16_bf16 v[96:111], v[204:207], v[192:195], v[96:111]
    ds_read_b128 v[208:211], v13 offset:49152
    ds_read_b64_tr_b16 v[220:221], v18 offset:13312
    s_waitcnt lgkmcnt(4)
    v_mfma_f32_32x32x16_bf16 v[80:95], v[200:203], v[196:199], v[80:95]
    ds_read_b64_tr_b16 v[222:223], v18 offset:13824
    v_mfma_f32_32x32x16_bf16 v[112:127], v[204:207], v[196:199], v[112:127]
    ds_read_b128 v[212:215], v13 offset:53248
    s_waitcnt lgkmcnt(3)
    v_mfma_f32_32x32x16_bf16 v[64:79], v[216:219], v[208:211], v[64:79]
    ds_read_b64_tr_b16 v[200:201], v18 offset:16384
    ds_read_b64_tr_b16 v[202:203], v18 offset:16896
    s_waitcnt lgkmcnt(3)
    v_mfma_f32_32x32x16_bf16 v[96:111], v[220:223], v[208:211], v[96:111]
    ds_read_b128 v[192:195], v14 offset:0
    ds_read_b64_tr_b16 v[204:205], v18 offset:17408
    s_waitcnt lgkmcnt(4)
    v_mfma_f32_32x32x16_bf16 v[80:95], v[216:219], v[212:215], v[80:95]
    ds_read_b64_tr_b16 v[206:207], v18 offset:17920
    v_mfma_f32_32x32x16_bf16 v[112:127], v[220:223], v[212:215], v[112:127]
    ds_read_b128 v[196:199], v14 offset:4096
    s_barrier
    s_waitcnt lgkmcnt(3)
    v_mfma_f32_32x32x16_bf16 v[64:79], v[200:203], v[192:195], v[64:79]
    ds_read_b64_tr_b16 v[216:217], v18 offset:20480
    ds_read_b64_tr_b16 v[218:219], v18 offset:20992
    s_waitcnt lgkmcnt(3)
    v_mfma_f32_32x32x16_bf16 v[96:111], v[204:207], v[192:195], v[96:111]
    ds_read_b128 v[208:211], v15 offset:0
    ds_read_b64_tr_b16 v[220:221], v18 offset:21504
    s_waitcnt lgkmcnt(4)
    v_mfma_f32_32x32x16_bf16 v[80:95], v[200:203], v[196:199], v[80:95]
    ds_read_b64_tr_b16 v[222:223], v18 offset:22016
    v_mfma_f32_32x32x16_bf16 v[112:127], v[204:207], v[196:199], v[112:127]
    ds_read_b128 v[212:215], v15 offset:4096
    s_waitcnt lgkmcnt(3)
    v_mfma_f32_32x32x16_bf16 v[64:79], v[216:219], v[208:211], v[64:79]
    ds_read_b64_tr_b16 v[200:201], v18 offset:24576
    ds_read_b64_tr_b16 v[202:203], v18 offset:25088
    s_waitcnt lgkmcnt(3)
    v_mfma_f32_32x32x16_bf16 v[96:111], v[220:223], v[208:211], v[96:111]
    ds_read_b128 v[192:195], v16 offset:0
    ds_read_b64_tr_b16 v[204:205], v18 offset:25600
    s_waitcnt lgkmcnt(4)
    v_mfma_f32_32x32x16_bf16 v[80:95], v[216:219], v[212:215], v[80:95]
    ds_read_b64_tr_b16 v[206:207], v18 offset:26112
    v_mfma_f32_32x32x16_bf16 v[112:127], v[220:223], v[212:215], v[112:127]
    ds_read_b128 v[196:199], v16 offset:4096
    s_barrier
    s_waitcnt lgkmcnt(3)
    v_mfma_f32_32x32x16_bf16 v[64:79], v[200:203], v[192:195], v[64:79]
    ds_read_b64_tr_b16 v[216:217], v18 offset:28672
    ds_read_b64_tr_b16 v[218:219], v18 offset:29184
    s_waitcnt lgkmcnt(3)
    v_mfma_f32_32x32x16_bf16 v[96:111], v[204:207], v[192:195], v[96:111]
    ds_read_b128 v[208:211], v17 offset:0
    ds_read_b64_tr_b16 v[220:221], v18 offset:29696
    s_waitcnt lgkmcnt(4)
    v_mfma_f32_32x32x16_bf16 v[80:95], v[200:203], v[196:199], v[80:95]
    ds_read_b64_tr_b16 v[222:223], v18 offset:30208
    v_mfma_f32_32x32x16_bf16 v[112:127], v[204:207], v[196:199], v[112:127]
    ds_read_b128 v[212:215], v17 offset:4096
    s_waitcnt lgkmcnt(3)
    v_mfma_f32_32x32x16_bf16 v[64:79], v[216:219], v[208:211], v[64:79]
    ds_read_b64_tr_b16 v[200:201], v18 offset:32768
    ds_read_b64_tr_b16 v[202:203], v18 offset:33280
    s_waitcnt lgkmcnt(3)
    v_mfma_f32_32x32x16_bf16 v[96:111], v[220:223], v[208:211], v[96:111]
    ds_read_b128 v[192:195], v14 offset:16384
    ds_read_b64_tr_b16 v[204:205], v18 offset:33792
    s_waitcnt lgkmcnt(4)
    v_mfma_f32_32x32x16_bf16 v[80:95], v[216:219], v[212:215], v[80:95]
    ds_read_b64_tr_b16 v[206:207], v18 offset:34304
    v_mfma_f32_32x32x16_bf16 v[112:127], v[220:223], v[212:215], v[112:127]
    ds_read_b128 v[196:199], v14 offset:20480
    s_barrier
    s_waitcnt lgkmcnt(3)
    v_mfma_f32_32x32x16_bf16 v[64:79], v[200:203], v[192:195], v[64:79]
    ds_read_b64_tr_b16 v[216:217], v18 offset:36864
    ds_read_b64_tr_b16 v[218:219], v18 offset:37376
    s_waitcnt lgkmcnt(3)
    v_mfma_f32_32x32x16_bf16 v[96:111], v[204:207], v[192:195], v[96:111]
    ds_read_b128 v[208:211], v15 offset:16384
    ds_read_b64_tr_b16 v[220:221], v18 offset:37888
    s_waitcnt lgkmcnt(4)
    v_mfma_f32_32x32x16_bf16 v[80:95], v[200:203], v[196:199], v[80:95]
    ds_read_b64_tr_b16 v[222:223], v18 offset:38400
    v_mfma_f32_32x32x16_bf16 v[112:127], v[204:207], v[196:199], v[112:127]
    ds_read_b128 v[212:215], v15 offset:20480
    s_waitcnt lgkmcnt(3)
    v_mfma_f32_32x32x16_bf16 v[64:79], v[216:219], v[208:211], v[64:79]
    ds_read_b64_tr_b16 v[200:201], v18 offset:40960
    ds_read_b64_tr_b16 v[202:203], v18 offset:41472
    s_waitcnt lgkmcnt(3)
    v_mfma_f32_32x32x16_bf16 v[96:111], v[220:223], v[208:211], v[96:111]
    ds_read_b128 v[192:195], v16 offset:16384
    ds_read_b64_tr_b16 v[204:205], v18 offset:41984
    s_waitcnt lgkmcnt(4)
    v_mfma_f32_32x32x16_bf16 v[80:95], v[216:219], v[212:215], v[80:95]
    ds_read_b64_tr_b16 v[206:207], v18 offset:42496
    v_mfma_f32_32x32x16_bf16 v[112:127], v[220:223], v[212:215], v[112:127]
    ds_read_b128 v[196:199], v16 offset:20480
    s_barrier
    s_waitcnt lgkmcnt(3)
    v_mfma_f32_32x32x16_bf16 v[64:79], v[200:203], v[192:195], v[64:79]
    ds_read_b64_tr_b16 v[216:217], v18 offset:45056
    ds_read_b64_tr_b16 v[218:219], v18 offset:45568
    s_waitcnt lgkmcnt(3)
    v_mfma_f32_32x32x16_bf16 v[96:111], v[204:207], v[192:195], v[96:111]
    ds_read_b128 v[208:211], v17 offset:16384
    ds_read_b64_tr_b16 v[220:221], v18 offset:46080
    s_waitcnt lgkmcnt(4)
    v_mfma_f32_32x32x16_bf16 v[80:95], v[200:203], v[196:199], v[80:95]
    ds_read_b64_tr_b16 v[222:223], v18 offset:46592
    v_mfma_f32_32x32x16_bf16 v[112:127], v[204:207], v[196:199], v[112:127]
    ds_read_b128 v[212:215], v17 offset:20480
    s_waitcnt lgkmcnt(3)
    v_mfma_f32_32x32x16_bf16 v[64:79], v[216:219], v[208:211], v[64:79]
    ds_read_b64_tr_b16 v[200:201], v18 offset:0
    ds_read_b64_tr_b16 v[202:203], v18 offset:512
    s_waitcnt lgkmcnt(3)
    v_mfma_f32_32x32x16_bf16 v[96:111], v[220:223], v[208:211], v[96:111]
    ds_read_b128 v[192:195], v14 offset:32768
    ds_read_b64_tr_b16 v[204:205], v18 offset:1024
    s_waitcnt lgkmcnt(4)
    v_mfma_f32_32x32x16_bf16 v[80:95], v[216:219], v[212:215], v[80:95]
    ds_read_b64_tr_b16 v[206:207], v18 offset:1536
    v_mfma_f32_32x32x16_bf16 v[112:127], v[220:223], v[212:215], v[112:127]
    ds_read_b128 v[196:199], v14 offset:36864
    s_barrier
    s_waitcnt lgkmcnt(3)
    v_mfma_f32_32x32x16_bf16 v[64:79], v[200:203], v[192:195], v[64:79]
    ds_read_b64_tr_b16 v[216:217], v18 offset:4096
    ds_read_b64_tr_b16 v[218:219], v18 offset:4608
    s_waitcnt lgkmcnt(3)
    v_mfma_f32_32x32x16_bf16 v[96:111], v[204:207], v[192:195], v[96:111]
    ds_read_b128 v[208:211], v15 offset:32768
    ds_read_b64_tr_b16 v[220:221], v18 offset:5120
    s_waitcnt lgkmcnt(4)
    v_mfma_f32_32x32x16_bf16 v[80:95], v[200:203], v[196:199], v[80:95]
    ds_read_b64_tr_b16 v[222:223], v18 offset:5632
    v_mfma_f32_32x32x16_bf16 v[112:127], v[204:207], v[196:199], v[112:127]
    ds_read_b128 v[212:215], v15 offset:36864
    s_waitcnt lgkmcnt(3)
    v_mfma_f32_32x32x16_bf16 v[64:79], v[216:219], v[208:211], v[64:79]
    ds_read_b64_tr_b16 v[200:201], v18 offset:8192
    ds_read_b64_tr_b16 v[202:203], v18 offset:8704
    s_waitcnt lgkmcnt(3)
    v_mfma_f32_32x32x16_bf16 v[96:111], v[220:223], v[208:211], v[96:111]
    ds_read_b128 v[192:195], v16 offset:32768
    ds_read_b64_tr_b16 v[204:205], v18 offset:9216
    s_waitcnt lgkmcnt(4)
    v_mfma_f32_32x32x16_bf16 v[80:95], v[216:219], v[212:215], v[80:95]
    ds_read_b64_tr_b16 v[206:207], v18 offset:9728
    v_mfma_f32_32x32x16_bf16 v[112:127], v[220:223], v[212:215], v[112:127]
    ds_read_b128 v[196:199], v16 offset:36864
    s_barrier
    s_waitcnt lgkmcnt(3)
    v_mfma_f32_32x32x16_bf16 v[64:79], v[200:203], v[192:195], v[64:79]
    ds_read_b64_tr_b16 v[216:217], v18 offset:12288
    ds_read_b64_tr_b16 v[218:219], v18 offset:12800
    s_waitcnt lgkmcnt(3)
    v_mfma_f32_32x32x16_bf16 v[96:111], v[204:207], v[192:195], v[96:111]
    ds_read_b128 v[208:211], v17 offset:32768
    ds_read_b64_tr_b16 v[220:221], v18 offset:13312
    s_waitcnt lgkmcnt(4)
    v_mfma_f32_32x32x16_bf16 v[80:95], v[200:203], v[196:199], v[80:95]
    ds_read_b64_tr_b16 v[222:223], v18 offset:13824
    v_mfma_f32_32x32x16_bf16 v[112:127], v[204:207], v[196:199], v[112:127]
    ds_read_b128 v[212:215], v17 offset:36864
    s_waitcnt lgkmcnt(3)
    v_mfma_f32_32x32x16_bf16 v[64:79], v[216:219], v[208:211], v[64:79]
    ds_read_b64_tr_b16 v[200:201], v18 offset:16384
    ds_read_b64_tr_b16 v[202:203], v18 offset:16896
    s_waitcnt lgkmcnt(3)
    v_mfma_f32_32x32x16_bf16 v[96:111], v[220:223], v[208:211], v[96:111]
    ds_read_b128 v[192:195], v10 offset:0
    ds_read_b64_tr_b16 v[204:205], v18 offset:17408
    s_waitcnt lgkmcnt(4)
    v_mfma_f32_32x32x16_bf16 v[80:95], v[216:219], v[212:215], v[80:95]
    ds_read_b64_tr_b16 v[206:207], v18 offset:17920
    v_mfma_f32_32x32x16_bf16 v[112:127], v[220:223], v[212:215], v[112:127]
    ds_read_b128 v[196:199], v10 offset:4096
    s_nop 7
    s_nop 3
    v_pk_mul_f32 v[64:65], v[64:65], s[44:45]
    v_pk_mul_f32 v[66:67], v[66:67], s[44:45]
    v_pk_mul_f32 v[68:69], v[68:69], s[44:45]
    v_pk_mul_f32 v[70:71], v[70:71], s[44:45]
    v_exp_f32 v64, v64
    v_exp_f32 v65, v65
    v_exp_f32 v66, v66
    v_exp_f32 v67, v67
    v_exp_f32 v68, v68
    v_exp_f32 v69, v69
    v_exp_f32 v70, v70
    v_exp_f32 v71, v71
    v_pk_add_f32 v[64:65], v[64:65], 1.0 op_sel_hi:[1,0]
    v_pk_add_f32 v[66:67], v[66:67], 1.0 op_sel_hi:[1,0]
    v_pk_add_f32 v[68:69], v[68:69], 1.0 op_sel_hi:[1,0]
    v_pk_add_f32 v[70:71], v[70:71], 1.0 op_sel_hi:[1,0]
    v_rcp_f32 v64, v64
    v_rcp_f32 v65, v65
    v_rcp_f32 v66, v66
    v_rcp_f32 v67, v67
    v_rcp_f32 v68, v68
    v_rcp_f32 v69, v69
    v_rcp_f32 v70, v70
    v_rcp_f32 v71, v71
    v_pk_mul_f32 v[64:65], v[64:65], v[96:97]
    v_pk_mul_f32 v[66:67], v[66:67], v[98:99]
    v_pk_mul_f32 v[68:69], v[68:69], v[100:101]
    v_pk_mul_f32 v[70:71], v[70:71], v[102:103]
    v_cvt_pk_bf16_f32 v224, v64, v65
    v_cvt_pk_bf16_f32 v225, v66, v67
    v_cvt_pk_bf16_f32 v226, v68, v69
    v_cvt_pk_bf16_f32 v227, v70, v71
    buffer_store_dwordx4 v[224:227], v20, s[20:23], 0 offen offset:0 sc1
    v_pk_mul_f32 v[72:73], v[72:73], s[44:45]
    v_pk_mul_f32 v[74:75], v[74:75], s[44:45]
    v_pk_mul_f32 v[76:77], v[76:77], s[44:45]
    v_pk_mul_f32 v[78:79], v[78:79], s[44:45]
    v_exp_f32 v72, v72
    v_exp_f32 v73, v73
    v_exp_f32 v74, v74
    v_exp_f32 v75, v75
    v_exp_f32 v76, v76
    v_exp_f32 v77, v77
    v_exp_f32 v78, v78
    v_exp_f32 v79, v79
    v_pk_add_f32 v[72:73], v[72:73], 1.0 op_sel_hi:[1,0]
    v_pk_add_f32 v[74:75], v[74:75], 1.0 op_sel_hi:[1,0]
    v_pk_add_f32 v[76:77], v[76:77], 1.0 op_sel_hi:[1,0]
    v_pk_add_f32 v[78:79], v[78:79], 1.0 op_sel_hi:[1,0]
    v_rcp_f32 v72, v72
    v_rcp_f32 v73, v73
    v_rcp_f32 v74, v74
    v_rcp_f32 v75, v75
    v_rcp_f32 v76, v76
    v_rcp_f32 v77, v77
    v_rcp_f32 v78, v78
    v_rcp_f32 v79, v79
    v_pk_mul_f32 v[72:73], v[72:73], v[104:105]
    v_pk_mul_f32 v[74:75], v[74:75], v[106:107]
    v_pk_mul_f32 v[76:77], v[76:77], v[108:109]
    v_pk_mul_f32 v[78:79], v[78:79], v[110:111]
    v_cvt_pk_bf16_f32 v228, v72, v73
    v_cvt_pk_bf16_f32 v229, v74, v75
    v_cvt_pk_bf16_f32 v230, v76, v77
    v_cvt_pk_bf16_f32 v231, v78, v79
    buffer_store_dwordx4 v[228:231], v20, s[20:23], 0 offen offset:2048 sc1
    v_pk_mul_f32 v[80:81], v[80:81], s[44:45]
    v_pk_mul_f32 v[82:83], v[82:83], s[44:45]
    v_pk_mul_f32 v[84:85], v[84:85], s[44:45]
    v_pk_mul_f32 v[86:87], v[86:87], s[44:45]
    v_exp_f32 v80, v80
    v_exp_f32 v81, v81
    v_exp_f32 v82, v82
    v_exp_f32 v83, v83
    v_exp_f32 v84, v84
    v_exp_f32 v85, v85
    v_exp_f32 v86, v86
    v_exp_f32 v87, v87
    v_pk_add_f32 v[80:81], v[80:81], 1.0 op_sel_hi:[1,0]
    v_pk_add_f32 v[82:83], v[82:83], 1.0 op_sel_hi:[1,0]
    v_pk_add_f32 v[84:85], v[84:85], 1.0 op_sel_hi:[1,0]
    v_pk_add_f32 v[86:87], v[86:87], 1.0 op_sel_hi:[1,0]
    v_rcp_f32 v80, v80
    v_rcp_f32 v81, v81
    v_rcp_f32 v82, v82
    v_rcp_f32 v83, v83
    v_rcp_f32 v84, v84
    v_rcp_f32 v85, v85
    v_rcp_f32 v86, v86
    v_rcp_f32 v87, v87
    v_pk_mul_f32 v[80:81], v[80:81], v[112:113]
    v_pk_mul_f32 v[82:83], v[82:83], v[114:115]
    v_pk_mul_f32 v[84:85], v[84:85], v[116:117]
    v_pk_mul_f32 v[86:87], v[86:87], v[118:119]
    v_cvt_pk_bf16_f32 v232, v80, v81
    v_cvt_pk_bf16_f32 v233, v82, v83
    v_cvt_pk_bf16_f32 v234, v84, v85
    v_cvt_pk_bf16_f32 v235, v86, v87
    buffer_store_dwordx4 v[232:235], v20, s[20:23], 0 offen offset:1024 sc1
    v_pk_mul_f32 v[88:89], v[88:89], s[44:45]
    v_pk_mul_f32 v[90:91], v[90:91], s[44:45]
    v_pk_mul_f32 v[92:93], v[92:93], s[44:45]
    v_pk_mul_f32 v[94:95], v[94:95], s[44:45]
    v_exp_f32 v88, v88
    v_exp_f32 v89, v89
    v_exp_f32 v90, v90
    v_exp_f32 v91, v91
    v_exp_f32 v92, v92
    v_exp_f32 v93, v93
    v_exp_f32 v94, v94
    v_exp_f32 v95, v95
    v_pk_add_f32 v[88:89], v[88:89], 1.0 op_sel_hi:[1,0]
    v_pk_add_f32 v[90:91], v[90:91], 1.0 op_sel_hi:[1,0]
    v_pk_add_f32 v[92:93], v[92:93], 1.0 op_sel_hi:[1,0]
    v_pk_add_f32 v[94:95], v[94:95], 1.0 op_sel_hi:[1,0]
    v_rcp_f32 v88, v88
    v_rcp_f32 v89, v89
    v_rcp_f32 v90, v90
    v_rcp_f32 v91, v91
    v_rcp_f32 v92, v92
    v_rcp_f32 v93, v93
    v_rcp_f32 v94, v94
    v_rcp_f32 v95, v95
    v_pk_mul_f32 v[88:89], v[88:89], v[120:121]
    v_pk_mul_f32 v[90:91], v[90:91], v[122:123]
    v_pk_mul_f32 v[92:93], v[92:93], v[124:125]
    v_pk_mul_f32 v[94:95], v[94:95], v[126:127]
    v_cvt_pk_bf16_f32 v236, v88, v89
    v_cvt_pk_bf16_f32 v237, v90, v91
    v_cvt_pk_bf16_f32 v238, v92, v93
    v_cvt_pk_bf16_f32 v239, v94, v95
    buffer_store_dwordx4 v[236:239], v20, s[20:23], 0 offen offset:3072 sc1
    s_barrier
    s_waitcnt lgkmcnt(3)
    v_mfma_f32_32x32x16_bf16 v[128:143], v[200:203], v[192:195], 0
    ds_read_b64_tr_b16 v[216:217], v18 offset:20480
    ds_read_b64_tr_b16 v[218:219], v18 offset:20992
    s_waitcnt lgkmcnt(3)
    v_mfma_f32_32x32x16_bf16 v[160:175], v[204:207], v[192:195], 0
    ds_read_b128 v[208:211], v11 offset:0
    ds_read_b64_tr_b16 v[220:221], v18 offset:21504
    s_waitcnt lgkmcnt(4)
    v_mfma_f32_32x32x16_bf16 v[144:159], v[200:203], v[196:199], 0
    ds_read_b64_tr_b16 v[222:223], v18 offset:22016
    v_mfma_f32_32x32x16_bf16 v[176:191], v[204:207], v[196:199], 0
    ds_read_b128 v[212:215], v11 offset:4096
    s_waitcnt lgkmcnt(3)
    v_mfma_f32_32x32x16_bf16 v[128:143], v[216:219], v[208:211], v[128:143]
    ds_read_b64_tr_b16 v[200:201], v18 offset:24576
    ds_read_b64_tr_b16 v[202:203], v18 offset:25088
    s_waitcnt lgkmcnt(3)
    v_mfma_f32_32x32x16_bf16 v[160:175], v[220:223], v[208:211], v[160:175]
    ds_read_b128 v[192:195], v12 offset:0
    ds_read_b64_tr_b16 v[204:205], v18 offset:25600
    s_waitcnt lgkmcnt(4)
    v_mfma_f32_32x32x16_bf16 v[144:159], v[216:219], v[212:215], v[144:159]
    ds_read_b64_tr_b16 v[206:207], v18 offset:26112
    v_mfma_f32_32x32x16_bf16 v[176:191], v[220:223], v[212:215], v[176:191]
    ds_read_b128 v[196:199], v12 offset:4096
    s_barrier
    s_waitcnt lgkmcnt(3)
    v_mfma_f32_32x32x16_bf16 v[128:143], v[200:203], v[192:195], v[128:143]
    ds_read_b64_tr_b16 v[216:217], v18 offset:28672
    ds_read_b64_tr_b16 v[218:219], v18 offset:29184
    s_waitcnt lgkmcnt(3)
    v_mfma_f32_32x32x16_bf16 v[160:175], v[204:207], v[192:195], v[160:175]
    ds_read_b128 v[208:211], v13 offset:0
    ds_read_b64_tr_b16 v[220:221], v18 offset:29696
    s_waitcnt lgkmcnt(4)
    v_mfma_f32_32x32x16_bf16 v[144:159], v[200:203], v[196:199], v[144:159]
    ds_read_b64_tr_b16 v[222:223], v18 offset:30208
    v_mfma_f32_32x32x16_bf16 v[176:191], v[204:207], v[196:199], v[176:191]
    ds_read_b128 v[212:215], v13 offset:4096
    s_waitcnt lgkmcnt(3)
    v_mfma_f32_32x32x16_bf16 v[128:143], v[216:219], v[208:211], v[128:143]
    ds_read_b64_tr_b16 v[200:201], v18 offset:32768
    ds_read_b64_tr_b16 v[202:203], v18 offset:33280
    s_waitcnt lgkmcnt(3)
    v_mfma_f32_32x32x16_bf16 v[160:175], v[220:223], v[208:211], v[160:175]
    ds_read_b128 v[192:195], v10 offset:16384
    ds_read_b64_tr_b16 v[204:205], v18 offset:33792
    s_waitcnt lgkmcnt(4)
    v_mfma_f32_32x32x16_bf16 v[144:159], v[216:219], v[212:215], v[144:159]
    ds_read_b64_tr_b16 v[206:207], v18 offset:34304
    v_mfma_f32_32x32x16_bf16 v[176:191], v[220:223], v[212:215], v[176:191]
    ds_read_b128 v[196:199], v10 offset:20480
    s_barrier
    s_waitcnt lgkmcnt(3)
    v_mfma_f32_32x32x16_bf16 v[128:143], v[200:203], v[192:195], v[128:143]
    ds_read_b64_tr_b16 v[216:217], v18 offset:36864
    ds_read_b64_tr_b16 v[218:219], v18 offset:37376
    s_waitcnt lgkmcnt(3)
    v_mfma_f32_32x32x16_bf16 v[160:175], v[204:207], v[192:195], v[160:175]
    ds_read_b128 v[208:211], v11 offset:16384
    ds_read_b64_tr_b16 v[220:221], v18 offset:37888
    s_waitcnt lgkmcnt(4)
    v_mfma_f32_32x32x16_bf16 v[144:159], v[200:203], v[196:199], v[144:159]
    ds_read_b64_tr_b16 v[222:223], v18 offset:38400
    v_mfma_f32_32x32x16_bf16 v[176:191], v[204:207], v[196:199], v[176:191]
    ds_read_b128 v[212:215], v11 offset:20480
    s_waitcnt lgkmcnt(3)
    v_mfma_f32_32x32x16_bf16 v[128:143], v[216:219], v[208:211], v[128:143]
    ds_read_b64_tr_b16 v[200:201], v18 offset:40960
    ds_read_b64_tr_b16 v[202:203], v18 offset:41472
    s_waitcnt lgkmcnt(3)
    v_mfma_f32_32x32x16_bf16 v[160:175], v[220:223], v[208:211], v[160:175]
    ds_read_b128 v[192:195], v12 offset:16384
    ds_read_b64_tr_b16 v[204:205], v18 offset:41984
    s_waitcnt lgkmcnt(4)
    v_mfma_f32_32x32x16_bf16 v[144:159], v[216:219], v[212:215], v[144:159]
    ds_read_b64_tr_b16 v[206:207], v18 offset:42496
    v_mfma_f32_32x32x16_bf16 v[176:191], v[220:223], v[212:215], v[176:191]
    ds_read_b128 v[196:199], v12 offset:20480
    s_barrier
    s_waitcnt lgkmcnt(3)
    v_mfma_f32_32x32x16_bf16 v[128:143], v[200:203], v[192:195], v[128:143]
    ds_read_b64_tr_b16 v[216:217], v18 offset:45056
    ds_read_b64_tr_b16 v[218:219], v18 offset:45568
    s_waitcnt lgkmcnt(3)
    v_mfma_f32_32x32x16_bf16 v[160:175], v[204:207], v[192:195], v[160:175]
    ds_read_b128 v[208:211], v13 offset:16384
    ds_read_b64_tr_b16 v[220:221], v18 offset:46080
    s_waitcnt lgkmcnt(4)
    v_mfma_f32_32x32x16_bf16 v[144:159], v[200:203], v[196:199], v[144:159]
    ds_read_b64_tr_b16 v[222:223], v18 offset:46592
    v_mfma_f32_32x32x16_bf16 v[176:191], v[204:207], v[196:199], v[176:191]
    ds_read_b128 v[212:215], v13 offset:20480
    s_waitcnt lgkmcnt(3)
    v_mfma_f32_32x32x16_bf16 v[128:143], v[216:219], v[208:211], v[128:143]
    ds_read_b64_tr_b16 v[200:201], v18 offset:0
    ds_read_b64_tr_b16 v[202:203], v18 offset:512
    s_waitcnt lgkmcnt(3)
    v_mfma_f32_32x32x16_bf16 v[160:175], v[220:223], v[208:211], v[160:175]
    ds_read_b128 v[192:195], v10 offset:32768
    ds_read_b64_tr_b16 v[204:205], v18 offset:1024
    s_waitcnt lgkmcnt(4)
    v_mfma_f32_32x32x16_bf16 v[144:159], v[216:219], v[212:215], v[144:159]
    ds_read_b64_tr_b16 v[206:207], v18 offset:1536
    v_mfma_f32_32x32x16_bf16 v[176:191], v[220:223], v[212:215], v[176:191]
    ds_read_b128 v[196:199], v10 offset:36864
    s_barrier
    s_waitcnt lgkmcnt(3)
    v_mfma_f32_32x32x16_bf16 v[128:143], v[200:203], v[192:195], v[128:143]
    ds_read_b64_tr_b16 v[216:217], v18 offset:4096
    ds_read_b64_tr_b16 v[218:219], v18 offset:4608
    s_waitcnt lgkmcnt(3)
    v_mfma_f32_32x32x16_bf16 v[160:175], v[204:207], v[192:195], v[160:175]
    ds_read_b128 v[208:211], v11 offset:32768
    ds_read_b64_tr_b16 v[220:221], v18 offset:5120
    s_waitcnt lgkmcnt(4)
    v_mfma_f32_32x32x16_bf16 v[144:159], v[200:203], v[196:199], v[144:159]
    ds_read_b64_tr_b16 v[222:223], v18 offset:5632
    v_mfma_f32_32x32x16_bf16 v[176:191], v[204:207], v[196:199], v[176:191]
    ds_read_b128 v[212:215], v11 offset:36864
    s_waitcnt lgkmcnt(3)
    v_mfma_f32_32x32x16_bf16 v[128:143], v[216:219], v[208:211], v[128:143]
    ds_read_b64_tr_b16 v[200:201], v18 offset:8192
    ds_read_b64_tr_b16 v[202:203], v18 offset:8704
    s_waitcnt lgkmcnt(3)
    v_mfma_f32_32x32x16_bf16 v[160:175], v[220:223], v[208:211], v[160:175]
    ds_read_b128 v[192:195], v12 offset:32768
    ds_read_b64_tr_b16 v[204:205], v18 offset:9216
    s_waitcnt lgkmcnt(4)
    v_mfma_f32_32x32x16_bf16 v[144:159], v[216:219], v[212:215], v[144:159]
    ds_read_b64_tr_b16 v[206:207], v18 offset:9728
    v_mfma_f32_32x32x16_bf16 v[176:191], v[220:223], v[212:215], v[176:191]
    ds_read_b128 v[196:199], v12 offset:36864
    s_barrier
    s_waitcnt lgkmcnt(3)
    v_mfma_f32_32x32x16_bf16 v[128:143], v[200:203], v[192:195], v[128:143]
    ds_read_b64_tr_b16 v[216:217], v18 offset:12288
    ds_read_b64_tr_b16 v[218:219], v18 offset:12800
    s_waitcnt lgkmcnt(3)
    v_mfma_f32_32x32x16_bf16 v[160:175], v[204:207], v[192:195], v[160:175]
    ds_read_b128 v[208:211], v13 offset:32768
    ds_read_b64_tr_b16 v[220:221], v18 offset:13312
    s_waitcnt lgkmcnt(4)
    v_mfma_f32_32x32x16_bf16 v[144:159], v[200:203], v[196:199], v[144:159]
    ds_read_b64_tr_b16 v[222:223], v18 offset:13824
    v_mfma_f32_32x32x16_bf16 v[176:191], v[204:207], v[196:199], v[176:191]
    ds_read_b128 v[212:215], v13 offset:36864
    s_waitcnt lgkmcnt(3)
    v_mfma_f32_32x32x16_bf16 v[128:143], v[216:219], v[208:211], v[128:143]
    ds_read_b64_tr_b16 v[200:201], v18 offset:16384
    ds_read_b64_tr_b16 v[202:203], v18 offset:16896
    s_waitcnt lgkmcnt(3)
    v_mfma_f32_32x32x16_bf16 v[160:175], v[220:223], v[208:211], v[160:175]
    ds_read_b128 v[192:195], v10 offset:49152
    ds_read_b64_tr_b16 v[204:205], v18 offset:17408
    s_waitcnt lgkmcnt(4)
    v_mfma_f32_32x32x16_bf16 v[144:159], v[216:219], v[212:215], v[144:159]
    ds_read_b64_tr_b16 v[206:207], v18 offset:17920
    v_mfma_f32_32x32x16_bf16 v[176:191], v[220:223], v[212:215], v[176:191]
    ds_read_b128 v[196:199], v10 offset:53248
    s_barrier
    s_waitcnt lgkmcnt(3)
    v_mfma_f32_32x32x16_bf16 v[128:143], v[200:203], v[192:195], v[128:143]
    ds_read_b64_tr_b16 v[216:217], v18 offset:20480
    ds_read_b64_tr_b16 v[218:219], v18 offset:20992
    s_waitcnt lgkmcnt(3)
    v_mfma_f32_32x32x16_bf16 v[160:175], v[204:207], v[192:195], v[160:175]
    ds_read_b128 v[208:211], v11 offset:49152
    ds_read_b64_tr_b16 v[220:221], v18 offset:21504
    s_waitcnt lgkmcnt(4)
    v_mfma_f32_32x32x16_bf16 v[144:159], v[200:203], v[196:199], v[144:159]
    ds_read_b64_tr_b16 v[222:223], v18 offset:22016
    v_mfma_f32_32x32x16_bf16 v[176:191], v[204:207], v[196:199], v[176:191]
    ds_read_b128 v[212:215], v11 offset:53248
    s_waitcnt lgkmcnt(3)
    v_mfma_f32_32x32x16_bf16 v[128:143], v[216:219], v[208:211], v[128:143]
    ds_read_b64_tr_b16 v[200:201], v18 offset:24576
    ds_read_b64_tr_b16 v[202:203], v18 offset:25088
    s_waitcnt lgkmcnt(3)
    v_mfma_f32_32x32x16_bf16 v[160:175], v[220:223], v[208:211], v[160:175]
    ds_read_b128 v[192:195], v12 offset:49152
    ds_read_b64_tr_b16 v[204:205], v18 offset:25600
    s_waitcnt lgkmcnt(4)
    v_mfma_f32_32x32x16_bf16 v[144:159], v[216:219], v[212:215], v[144:159]
    ds_read_b64_tr_b16 v[206:207], v18 offset:26112
    v_mfma_f32_32x32x16_bf16 v[176:191], v[220:223], v[212:215], v[176:191]
    ds_read_b128 v[196:199], v12 offset:53248
    s_barrier
    s_waitcnt lgkmcnt(3)
    v_mfma_f32_32x32x16_bf16 v[128:143], v[200:203], v[192:195], v[128:143]
    ds_read_b64_tr_b16 v[216:217], v18 offset:28672
    ds_read_b64_tr_b16 v[218:219], v18 offset:29184
    s_waitcnt lgkmcnt(3)
    v_mfma_f32_32x32x16_bf16 v[160:175], v[204:207], v[192:195], v[160:175]
    ds_read_b128 v[208:211], v13 offset:49152
    ds_read_b64_tr_b16 v[220:221], v18 offset:29696
    s_waitcnt lgkmcnt(4)
    v_mfma_f32_32x32x16_bf16 v[144:159], v[200:203], v[196:199], v[144:159]
    ds_read_b64_tr_b16 v[222:223], v18 offset:30208
    v_mfma_f32_32x32x16_bf16 v[176:191], v[204:207], v[196:199], v[176:191]
    ds_read_b128 v[212:215], v13 offset:53248
    s_waitcnt lgkmcnt(3)
    v_mfma_f32_32x32x16_bf16 v[128:143], v[216:219], v[208:211], v[128:143]
    ds_read_b64_tr_b16 v[200:201], v18 offset:32768
    ds_read_b64_tr_b16 v[202:203], v18 offset:33280
    s_waitcnt lgkmcnt(3)
    v_mfma_f32_32x32x16_bf16 v[160:175], v[220:223], v[208:211], v[160:175]
    ds_read_b128 v[192:195], v14 offset:0
    ds_read_b64_tr_b16 v[204:205], v18 offset:33792
    s_waitcnt lgkmcnt(4)
    v_mfma_f32_32x32x16_bf16 v[144:159], v[216:219], v[212:215], v[144:159]
    ds_read_b64_tr_b16 v[206:207], v18 offset:34304
    v_mfma_f32_32x32x16_bf16 v[176:191], v[220:223], v[212:215], v[176:191]
    ds_read_b128 v[196:199], v14 offset:4096
    s_waitcnt vmcnt(0)
    s_barrier
    s_waitcnt lgkmcnt(3)
    v_mfma_f32_32x32x16_bf16 v[128:143], v[200:203], v[192:195], v[128:143]
    ds_read_b64_tr_b16 v[216:217], v18 offset:36864
    ds_read_b64_tr_b16 v[218:219], v18 offset:37376
    s_waitcnt lgkmcnt(3)
    v_mfma_f32_32x32x16_bf16 v[160:175], v[204:207], v[192:195], v[160:175]
    ds_read_b128 v[208:211], v15 offset:0
    ds_read_b64_tr_b16 v[220:221], v18 offset:37888
    s_waitcnt lgkmcnt(4)
    v_mfma_f32_32x32x16_bf16 v[144:159], v[200:203], v[196:199], v[144:159]
    ds_read_b64_tr_b16 v[222:223], v18 offset:38400
    v_mfma_f32_32x32x16_bf16 v[176:191], v[204:207], v[196:199], v[176:191]
    ds_read_b128 v[212:215], v15 offset:4096
    s_waitcnt lgkmcnt(3)
    v_mfma_f32_32x32x16_bf16 v[128:143], v[216:219], v[208:211], v[128:143]
    ds_read_b64_tr_b16 v[200:201], v18 offset:40960
    ds_read_b64_tr_b16 v[202:203], v18 offset:41472
    s_waitcnt lgkmcnt(3)
    v_mfma_f32_32x32x16_bf16 v[160:175], v[220:223], v[208:211], v[160:175]
    ds_read_b128 v[192:195], v16 offset:0
    ds_read_b64_tr_b16 v[204:205], v18 offset:41984
    s_waitcnt lgkmcnt(4)
    v_mfma_f32_32x32x16_bf16 v[144:159], v[216:219], v[212:215], v[144:159]
    ds_read_b64_tr_b16 v[206:207], v18 offset:42496
    v_mfma_f32_32x32x16_bf16 v[176:191], v[220:223], v[212:215], v[176:191]
    ds_read_b128 v[196:199], v16 offset:4096
    s_barrier
    s_waitcnt lgkmcnt(3)
    v_mfma_f32_32x32x16_bf16 v[128:143], v[200:203], v[192:195], v[128:143]
    ds_read_b64_tr_b16 v[216:217], v18 offset:45056
    ds_read_b64_tr_b16 v[218:219], v18 offset:45568
    s_waitcnt lgkmcnt(3)
    v_mfma_f32_32x32x16_bf16 v[160:175], v[204:207], v[192:195], v[160:175]
    ds_read_b128 v[208:211], v17 offset:0
    ds_read_b64_tr_b16 v[220:221], v18 offset:46080
    s_waitcnt lgkmcnt(4)
    v_mfma_f32_32x32x16_bf16 v[144:159], v[200:203], v[196:199], v[144:159]
    ds_read_b64_tr_b16 v[222:223], v18 offset:46592
    v_mfma_f32_32x32x16_bf16 v[176:191], v[204:207], v[196:199], v[176:191]
    ds_read_b128 v[212:215], v17 offset:4096
    buffer_load_dword v4, v7, s[36:39], 0 offen sc1
    s_waitcnt lgkmcnt(3)
    v_mfma_f32_32x32x16_bf16 v[128:143], v[216:219], v[208:211], v[128:143]
    ds_read_b64_tr_b16 v[200:201], v18 offset:0
    ds_read_b64_tr_b16 v[202:203], v18 offset:512
    s_waitcnt lgkmcnt(3)
    v_mfma_f32_32x32x16_bf16 v[160:175], v[220:223], v[208:211], v[160:175]
    ds_read_b128 v[192:195], v14 offset:16384
    ds_read_b64_tr_b16 v[204:205], v18 offset:1024
    s_waitcnt lgkmcnt(4)
    v_mfma_f32_32x32x16_bf16 v[144:159], v[216:219], v[212:215], v[144:159]
    ds_read_b64_tr_b16 v[206:207], v18 offset:1536
    v_mfma_f32_32x32x16_bf16 v[176:191], v[220:223], v[212:215], v[176:191]
    ds_read_b128 v[196:199], v14 offset:20480
    s_barrier
    s_waitcnt lgkmcnt(3)
    v_mfma_f32_32x32x16_bf16 v[128:143], v[200:203], v[192:195], v[128:143]
    ds_read_b64_tr_b16 v[216:217], v18 offset:4096
    ds_read_b64_tr_b16 v[218:219], v18 offset:4608
    s_waitcnt lgkmcnt(3)
    v_mfma_f32_32x32x16_bf16 v[160:175], v[204:207], v[192:195], v[160:175]
    ds_read_b128 v[208:211], v15 offset:16384
    ds_read_b64_tr_b16 v[220:221], v18 offset:5120
    s_waitcnt lgkmcnt(4)
    v_mfma_f32_32x32x16_bf16 v[144:159], v[200:203], v[196:199], v[144:159]
    ds_read_b64_tr_b16 v[222:223], v18 offset:5632
    v_mfma_f32_32x32x16_bf16 v[176:191], v[204:207], v[196:199], v[176:191]
    ds_read_b128 v[212:215], v15 offset:20480
    s_waitcnt lgkmcnt(3)
    v_mfma_f32_32x32x16_bf16 v[128:143], v[216:219], v[208:211], v[128:143]
    ds_read_b64_tr_b16 v[200:201], v18 offset:8192
    ds_read_b64_tr_b16 v[202:203], v18 offset:8704
    s_waitcnt lgkmcnt(3)
    v_mfma_f32_32x32x16_bf16 v[160:175], v[220:223], v[208:211], v[160:175]
    ds_read_b128 v[192:195], v16 offset:16384
    ds_read_b64_tr_b16 v[204:205], v18 offset:9216
    s_waitcnt lgkmcnt(4)
    v_mfma_f32_32x32x16_bf16 v[144:159], v[216:219], v[212:215], v[144:159]
    ds_read_b64_tr_b16 v[206:207], v18 offset:9728
    v_mfma_f32_32x32x16_bf16 v[176:191], v[220:223], v[212:215], v[176:191]
    ds_read_b128 v[196:199], v16 offset:20480
    s_barrier
    s_waitcnt lgkmcnt(3)
    v_mfma_f32_32x32x16_bf16 v[128:143], v[200:203], v[192:195], v[128:143]
    ds_read_b64_tr_b16 v[216:217], v18 offset:12288
    ds_read_b64_tr_b16 v[218:219], v18 offset:12800
    s_waitcnt lgkmcnt(3)
    v_mfma_f32_32x32x16_bf16 v[160:175], v[204:207], v[192:195], v[160:175]
    ds_read_b128 v[208:211], v17 offset:16384
    ds_read_b64_tr_b16 v[220:221], v18 offset:13312
    s_waitcnt lgkmcnt(4)
    v_mfma_f32_32x32x16_bf16 v[144:159], v[200:203], v[196:199], v[144:159]
    ds_read_b64_tr_b16 v[222:223], v18 offset:13824
    v_mfma_f32_32x32x16_bf16 v[176:191], v[204:207], v[196:199], v[176:191]
    ds_read_b128 v[212:215], v17 offset:20480
    s_waitcnt lgkmcnt(3)
    v_mfma_f32_32x32x16_bf16 v[128:143], v[216:219], v[208:211], v[128:143]
    ds_read_b64_tr_b16 v[200:201], v18 offset:16384
    ds_read_b64_tr_b16 v[202:203], v18 offset:16896
    s_waitcnt lgkmcnt(3)
    v_mfma_f32_32x32x16_bf16 v[160:175], v[220:223], v[208:211], v[160:175]
    ds_read_b128 v[192:195], v14 offset:32768
    ds_read_b64_tr_b16 v[204:205], v18 offset:17408
    s_waitcnt lgkmcnt(4)
    v_mfma_f32_32x32x16_bf16 v[144:159], v[216:219], v[212:215], v[144:159]
    ds_read_b64_tr_b16 v[206:207], v18 offset:17920
    v_mfma_f32_32x32x16_bf16 v[176:191], v[220:223], v[212:215], v[176:191]
    ds_read_b128 v[196:199], v14 offset:36864
    s_barrier
    s_waitcnt lgkmcnt(3)
    v_mfma_f32_32x32x16_bf16 v[128:143], v[200:203], v[192:195], v[128:143]
    ds_read_b64_tr_b16 v[216:217], v18 offset:20480
    ds_read_b64_tr_b16 v[218:219], v18 offset:20992
    s_waitcnt lgkmcnt(3)
    v_mfma_f32_32x32x16_bf16 v[160:175], v[204:207], v[192:195], v[160:175]
    ds_read_b128 v[208:211], v15 offset:32768
    ds_read_b64_tr_b16 v[220:221], v18 offset:21504
    s_waitcnt lgkmcnt(4)
    v_mfma_f32_32x32x16_bf16 v[144:159], v[200:203], v[196:199], v[144:159]
    ds_read_b64_tr_b16 v[222:223], v18 offset:22016
    v_mfma_f32_32x32x16_bf16 v[176:191], v[204:207], v[196:199], v[176:191]
    ds_read_b128 v[212:215], v15 offset:36864
    s_waitcnt lgkmcnt(3)
    v_mfma_f32_32x32x16_bf16 v[128:143], v[216:219], v[208:211], v[128:143]
    ds_read_b64_tr_b16 v[200:201], v18 offset:24576
    ds_read_b64_tr_b16 v[202:203], v18 offset:25088
    s_waitcnt lgkmcnt(3)
    v_mfma_f32_32x32x16_bf16 v[160:175], v[220:223], v[208:211], v[160:175]
    ds_read_b128 v[192:195], v16 offset:32768
    ds_read_b64_tr_b16 v[204:205], v18 offset:25600
    s_waitcnt lgkmcnt(4)
    v_mfma_f32_32x32x16_bf16 v[144:159], v[216:219], v[212:215], v[144:159]
    ds_read_b64_tr_b16 v[206:207], v18 offset:26112
    v_mfma_f32_32x32x16_bf16 v[176:191], v[220:223], v[212:215], v[176:191]
    ds_read_b128 v[196:199], v16 offset:36864
    s_barrier
    s_waitcnt lgkmcnt(3)
    v_mfma_f32_32x32x16_bf16 v[128:143], v[200:203], v[192:195], v[128:143]
    ds_read_b64_tr_b16 v[216:217], v18 offset:28672
    ds_read_b64_tr_b16 v[218:219], v18 offset:29184
    s_waitcnt lgkmcnt(3)
    v_mfma_f32_32x32x16_bf16 v[160:175], v[204:207], v[192:195], v[160:175]
    ds_read_b128 v[208:211], v17 offset:32768
    ds_read_b64_tr_b16 v[220:221], v18 offset:29696
    s_waitcnt lgkmcnt(4)
    v_mfma_f32_32x32x16_bf16 v[144:159], v[200:203], v[196:199], v[144:159]
    ds_read_b64_tr_b16 v[222:223], v18 offset:30208
    v_mfma_f32_32x32x16_bf16 v[176:191], v[204:207], v[196:199], v[176:191]
    ds_read_b128 v[212:215], v17 offset:36864
    s_waitcnt lgkmcnt(3)
    v_mfma_f32_32x32x16_bf16 v[128:143], v[216:219], v[208:211], v[128:143]
    s_waitcnt lgkmcnt(1)
    v_mfma_f32_32x32x16_bf16 v[160:175], v[220:223], v[208:211], v[160:175]
    s_waitcnt lgkmcnt(0)
    v_mfma_f32_32x32x16_bf16 v[144:159], v[216:219], v[212:215], v[144:159]
    v_mfma_f32_32x32x16_bf16 v[176:191], v[220:223], v[212:215], v[176:191]
    s_barrier
    s_mov_b32 s42, 0
NTA_10:
    s_waitcnt vmcnt(0)
NCK_11:
    v_readfirstlane_b32 s98, v4
    s_nop 3
    s_cmp_lg_u32 s98, 0
    s_cbranch_scc1 NFA_9
    s_add_u32 s42, s42, 1
    s_cmp_ge_u32 s42, 0x40000
    s_cbranch_scc1 NFA_9
    s_sleep 1
    buffer_load_dword v4, v7, s[36:39], 0 offen sc1
    s_branch NTA_10
NFA_9:
    s_and_b32 s41, s2, 7
    s_lshr_b32 s42, s2, 3
    s_mul_i32 s43, s42, 37
    s_lshr_b32 s43, s43, 8
    s_mul_i32 s76, s43, 7
    s_sub_u32 s71, s42, s76
    s_lshl_b32 s41, s41, 2
    s_add_u32 s70, s41, s43
    s_lshr_b32 s43, s70, 1
    s_lshl_b32 s43, s43, 9
    s_add_u32 s100, s43, 0x910000
    v_lshlrev_b32 v61, 2, v1
    v_add_u32 v62, 0x912000, v61
    v_add_u32 v61, s100, v61
    v_cmp_gt_u32 vcc, 14, v1
    v_mov_b32 v60, 0x7fffffff
    s_nop 0
    v_cndmask_b32 v61, v60, v61, vcc
    v_cmp_lt_u32 vcc, 31, v1
    s_nop 1
    v_cndmask_b32 v61, v61, v62, vcc
    buffer_load_dword v60, v61, s[20:23], 0 offen sc1
    s_nop 7
    s_nop 3
    v_pk_mul_f32 v[128:129], v[128:129], s[44:45]
    v_pk_mul_f32 v[130:131], v[130:131], s[44:45]
    v_pk_mul_f32 v[132:133], v[132:133], s[44:45]
    v_pk_mul_f32 v[134:135], v[134:135], s[44:45]
    v_exp_f32 v128, v128
    v_exp_f32 v129, v129
    v_exp_f32 v130, v130
    v_exp_f32 v131, v131
    v_exp_f32 v132, v132
    v_exp_f32 v133, v133
    v_exp_f32 v134, v134
    v_exp_f32 v135, v135
    v_pk_add_f32 v[128:129], v[128:129], 1.0 op_sel_hi:[1,0]
    v_pk_add_f32 v[130:131], v[130:131], 1.0 op_sel_hi:[1,0]
    v_pk_add_f32 v[132:133], v[132:133], 1.0 op_sel_hi:[1,0]
    v_pk_add_f32 v[134:135], v[134:135], 1.0 op_sel_hi:[1,0]
    v_rcp_f32 v128, v128
    v_rcp_f32 v129, v129
    v_rcp_f32 v130, v130
    v_rcp_f32 v131, v131
    v_rcp_f32 v132, v132
    v_rcp_f32 v133, v133
    v_rcp_f32 v134, v134
    v_rcp_f32 v135, v135
    v_pk_mul_f32 v[128:129], v[128:129], v[160:161]
    v_pk_mul_f32 v[130:131], v[130:131], v[162:163]
    v_pk_mul_f32 v[132:133], v[132:133], v[164:165]
    v_pk_mul_f32 v[134:135], v[134:135], v[166:167]
    v_cvt_pk_bf16_f32 v224, v128, v129
    v_cvt_pk_bf16_f32 v225, v130, v131
    v_cvt_pk_bf16_f32 v226, v132, v133
    v_cvt_pk_bf16_f32 v227, v134, v135
    buffer_store_dwordx4 v[224:227], v21, s[20:23], 0 offen offset:0 sc1
    v_pk_mul_f32 v[136:137], v[136:137], s[44:45]
    v_pk_mul_f32 v[138:139], v[138:139], s[44:45]
    v_pk_mul_f32 v[140:141], v[140:141], s[44:45]
    v_pk_mul_f32 v[142:143], v[142:143], s[44:45]
    v_exp_f32 v136, v136
    v_exp_f32 v137, v137
    v_exp_f32 v138, v138
    v_exp_f32 v139, v139
    v_exp_f32 v140, v140
    v_exp_f32 v141, v141
    v_exp_f32 v142, v142
    v_exp_f32 v143, v143
    v_pk_add_f32 v[136:137], v[136:137], 1.0 op_sel_hi:[1,0]
    v_pk_add_f32 v[138:139], v[138:139], 1.0 op_sel_hi:[1,0]
    v_pk_add_f32 v[140:141], v[140:141], 1.0 op_sel_hi:[1,0]
    v_pk_add_f32 v[142:143], v[142:143], 1.0 op_sel_hi:[1,0]
    v_rcp_f32 v136, v136
    v_rcp_f32 v137, v137
    v_rcp_f32 v138, v138
    v_rcp_f32 v139, v139
    v_rcp_f32 v140, v140
    v_rcp_f32 v141, v141
    v_rcp_f32 v142, v142
    v_rcp_f32 v143, v143
    v_pk_mul_f32 v[136:137], v[136:137], v[168:169]
    v_pk_mul_f32 v[138:139], v[138:139], v[170:171]
    v_pk_mul_f32 v[140:141], v[140:141], v[172:173]
    v_pk_mul_f32 v[142:143], v[142:143], v[174:175]
    v_cvt_pk_bf16_f32 v228, v136, v137
    v_cvt_pk_bf16_f32 v229, v138, v139
    v_cvt_pk_bf16_f32 v230, v140, v141
    v_cvt_pk_bf16_f32 v231, v142, v143
    buffer_store_dwordx4 v[228:231], v21, s[20:23], 0 offen offset:2048 sc1
    v_pk_mul_f32 v[144:145], v[144:145], s[44:45]
    v_pk_mul_f32 v[146:147], v[146:147], s[44:45]
    v_pk_mul_f32 v[148:149], v[148:149], s[44:45]
    v_pk_mul_f32 v[150:151], v[150:151], s[44:45]
    v_exp_f32 v144, v144
    v_exp_f32 v145, v145
    v_exp_f32 v146, v146
    v_exp_f32 v147, v147
    v_exp_f32 v148, v148
    v_exp_f32 v149, v149
    v_exp_f32 v150, v150
    v_exp_f32 v151, v151
    v_pk_add_f32 v[144:145], v[144:145], 1.0 op_sel_hi:[1,0]
    v_pk_add_f32 v[146:147], v[146:147], 1.0 op_sel_hi:[1,0]
    v_pk_add_f32 v[148:149], v[148:149], 1.0 op_sel_hi:[1,0]
    v_pk_add_f32 v[150:151], v[150:151], 1.0 op_sel_hi:[1,0]
    v_rcp_f32 v144, v144
    v_rcp_f32 v145, v145
    v_rcp_f32 v146, v146
    v_rcp_f32 v147, v147
    v_rcp_f32 v148, v148
    v_rcp_f32 v149, v149
    v_rcp_f32 v150, v150
    v_rcp_f32 v151, v151
    v_pk_mul_f32 v[144:145], v[144:145], v[176:177]
    v_pk_mul_f32 v[146:147], v[146:147], v[178:179]
    v_pk_mul_f32 v[148:149], v[148:149], v[180:181]
    v_pk_mul_f32 v[150:151], v[150:151], v[182:183]
    v_cvt_pk_bf16_f32 v232, v144, v145
    v_cvt_pk_bf16_f32 v233, v146, v147
    v_cvt_pk_bf16_f32 v234, v148, v149
    v_cvt_pk_bf16_f32 v235, v150, v151
    buffer_store_dwordx4 v[232:235], v21, s[20:23], 0 offen offset:1024 sc1
    v_pk_mul_f32 v[152:153], v[152:153], s[44:45]
    v_pk_mul_f32 v[154:155], v[154:155], s[44:45]
    v_pk_mul_f32 v[156:157], v[156:157], s[44:45]
    v_pk_mul_f32 v[158:159], v[158:159], s[44:45]
    v_exp_f32 v152, v152
    v_exp_f32 v153, v153
    v_exp_f32 v154, v154
    v_exp_f32 v155, v155
    v_exp_f32 v156, v156
    v_exp_f32 v157, v157
    v_exp_f32 v158, v158
    v_exp_f32 v159, v159
    v_pk_add_f32 v[152:153], v[152:153], 1.0 op_sel_hi:[1,0]
    v_pk_add_f32 v[154:155], v[154:155], 1.0 op_sel_hi:[1,0]
    v_pk_add_f32 v[156:157], v[156:157], 1.0 op_sel_hi:[1,0]
    v_pk_add_f32 v[158:159], v[158:159], 1.0 op_sel_hi:[1,0]
    v_rcp_f32 v152, v152
    v_rcp_f32 v153, v153
    v_rcp_f32 v154, v154
    v_rcp_f32 v155, v155
    v_rcp_f32 v156, v156
    v_rcp_f32 v157, v157
    v_rcp_f32 v158, v158
    v_rcp_f32 v159, v159
    v_pk_mul_f32 v[152:153], v[152:153], v[184:185]
    v_pk_mul_f32 v[154:155], v[154:155], v[186:187]
    v_pk_mul_f32 v[156:157], v[156:157], v[188:189]
    v_pk_mul_f32 v[158:159], v[158:159], v[190:191]
    v_cvt_pk_bf16_f32 v236, v152, v153
    v_cvt_pk_bf16_f32 v237, v154, v155
    v_cvt_pk_bf16_f32 v238, v156, v157
    v_cvt_pk_bf16_f32 v239, v158, v159
    buffer_store_dwordx4 v[236:239], v21, s[20:23], 0 offen offset:3072 sc1
    s_and_b32 s3, s40, 3
    v_lshrrev_b32 v2, 3, v1
    v_bfe_u32 v3, v1, 4, 1
    v_lshlrev_b32 v3, 2, v3
    v_and_b32 v8, 7, v1
    v_xor_b32 v3, v3, v8
    v_lshlrev_b32 v3, 4, v3
    s_mul_i32 s41, s3, 224
    s_add_u32 s41, s41, 896
    v_add_u32 v2, s41, v2
    s_movk_i32 s42, 896
    v_mul_lo_u32 v2, v2, s42
    s_lshl_b32 s41, s71, 7
    v_add3_u32 v26, v2, v3, s41
    v_add_u32 v27, 6144, v26
    v_add_u32 v28, 12288, v26
    v_add_u32 v29, 18432, v26
    s_lshl_b32 s62, s3, 12
    s_and_b32 s4, s70, 3
    s_lshl_b32 s4, s4, 1
    s_add_u32 s4, s4, s71
    s_cmp_ge_u32 s4, 7
    s_cselect_b32 s5, 7, 0
    s_sub_u32 s4, s4, s5
    s_mov_b32 s4, 0
    v_and_b32 v2, 15, v1
    v_lshrrev_b32 v3, 2, v2
    v_lshrrev_b32 v8, 5, v1
    v_lshlrev_b32 v5, 2, v8
    v_add_u32 v5, v5, v3
    v_lshlrev_b32 v5, 7, v5
    v_bfe_u32 v6, v2, 3, 1
    v_lshlrev_b32 v6, 6, v6
    v_bfe_u32 v3, v1, 4, 1
    v_lshlrev_b32 v3, 5, v3
    v_and_b32 v8, 3, v2
    v_lshlrev_b32 v8, 3, v8
    v_add3_u32 v5, v5, v6, v3
    v_add_u32 v5, v5, v8
    v_add_u32 v11, s62, v5
    v_xor_b32 v12, 64, v11
    v_add_u32 v18, 0x10000, v11
    v_add_u32 v19, 0x10000, v12
    v_add_u32 v15, 0x20000, v11
    v_add_u32 v63, 0x20000, v12
    s_mul_i32 s41, s70, 112
    s_mul_i32 s42, s3, 14
    s_add_u32 s41, s41, s42
    s_add_u32 s41, s41, 56
    s_lshl_b32 s41, s41, 11
    v_lshlrev_b32 v13, 4, v1
    v_add_u32 v13, s41, v13
    v_and_b32 v14, 31, v1
    v_subrev_u32 v9, 114688, v13
    s_mov_b32 s28, s46
    s_and_b32 s29, s47, 0xffff
    s_mov_b32 s30, 0x1c0000
    s_mov_b32 s31, 0x20000
    s_mov_b32 s32, s56
    s_and_b32 s33, s57, 0xffff
    s_mov_b32 s34, 0x188000
    s_mov_b32 s35, 0x20000
    s_mov_b32 s5, s4
    s_mul_i32 s44, s5, 28672
    s_add_u32 s5, s5, 1
    s_cmp_eq_u32 s5, 7
    s_cselect_b32 s5, 0, s5
    s_mul_i32 s45, s5, 28672
    s_add_u32 s5, s5, 1
    s_cmp_eq_u32 s5, 7
    s_cselect_b32 s5, 0, s5
    s_mul_i32 s46, s5, 28672
    s_add_u32 s5, s5, 1
    s_cmp_eq_u32 s5, 7
    s_cselect_b32 s5, 0, s5
    s_mul_i32 s47, s5, 28672
    s_add_u32 s5, s5, 1
    s_cmp_eq_u32 s5, 7
    s_cselect_b32 s5, 0, s5
    s_mul_i32 s48, s5, 28672
    s_add_u32 s5, s5, 1
    s_cmp_eq_u32 s5, 7
    s_cselect_b32 s5, 0, s5
    s_mul_i32 s49, s5, 28672
    s_add_u32 s5, s5, 1
    s_cmp_eq_u32 s5, 7
    s_cselect_b32 s5, 0, s5
    s_mul_i32 s50, s5, 28672
    s_mov_b32 s5, s4
    s_mul_i32 s51, s5, 4096
    s_add_u32 s5, s5, 1
    s_cmp_eq_u32 s5, 7
    s_cselect_b32 s5, 0, s5
    s_mul_i32 s52, s5, 4096
    s_add_u32 s5, s5, 1
    s_cmp_eq_u32 s5, 7
    s_cselect_b32 s5, 0, s5
    s_mul_i32 s53, s5, 4096
    s_add_u32 s5, s5, 1
    s_cmp_eq_u32 s5, 7
    s_cselect_b32 s5, 0, s5
    s_mul_i32 s54, s5, 4096
    s_add_u32 s5, s5, 1
    s_cmp_eq_u32 s5, 7
    s_cselect_b32 s5, 0, s5
    s_mul_i32 s55, s5, 4096
    s_add_u32 s5, s5, 1
    s_cmp_eq_u32 s5, 7
    s_cselect_b32 s5, 0, s5
    s_mul_i32 s56, s5, 4096
    s_add_u32 s5, s5, 1
    s_cmp_eq_u32 s5, 7
    s_cselect_b32 s5, 0, s5
    s_mul_i32 s57, s5, 4096
    s_waitcnt vmcnt(4)
    s_mov_b32 s41, 0
ATOP_13:
    v_cmp_eq_u32 vcc, s98, v60
    s_nop 1
    s_and_b32 s42, vcc_lo, 0x3fff
    s_cmp_eq_u32 s42, 0x3fff
    s_cselect_b32 s42, vcc_hi, 0
    s_cmp_eq_u32 s42, -1
    s_cbranch_scc1 AOK_12
    s_add_u32 s41, s41, 1
    s_cmp_ge_u32 s41, 0x40000
    s_cbranch_scc1 AOK_12
    buffer_load_dword v60, v61, s[20:23], 0 offen sc1
    s_waitcnt vmcnt(0)
    s_branch ATOP_13
AOK_12:
    s_cmp_ge_u32 s71, 4
    s_cselect_b32 s63, 1, 0
    s_sub_u32 s64, 32, s70
    s_and_b32 s64, s64, 31
    s_cmp_eq_u32 s63, 1
    s_cselect_b32 s64, s64, s70
    v_lshrrev_b32 v8, 5, v1
    s_lshl_b32 s41, s71, 6
    s_cmp_eq_u32 s63, 1
    s_cselect_b64 vcc, -1, 0
    v_add_u32 v2, s41, v14
    v_sub_u32 v3, 448, v2
    v_cndmask_b32 v2, v2, v3, vcc
    v_lshlrev_b32 v2, 4, v2
    v_lshlrev_b32 v3, 12, v8
    v_add_u32 v16, v2, v3
    v_add_u32 v2, s41, v14
    v_add_u32 v2, 32, v2
    v_sub_u32 v3, 448, v2
    v_cndmask_b32 v2, v2, v3, vcc
    v_lshlrev_b32 v2, 4, v2
    v_lshlrev_b32 v3, 12, v8
    v_add_u32 v17, v2, v3
    s_lshl_b32 s41, s64, 4
    s_lshl_b32 s42, s3, 2
    s_add_u32 s41, s41, s42
    s_lshl_b32 s41, s41, 12
    s_add_u32 s65, s41, 0x700000
    s_lshl_b32 s41, s70, 6
    v_add_u32 v2, s41, v14
    v_lshlrev_b32 v2, 2, v2
    v_add_u32 v20, 0x900000, v2
    s_mul_i32 s41, s61, 12
    s_lshl_b32 s42, s40, 2
    s_add_u32 s41, s41, s42
    s_add_u32 s41, s41, 256
    s_add_u32 s99, s99, s41
    s_waitcnt vmcnt(0)
    v_mov_b32 v60, s98
    v_lshlrev_b32 v61, 24, v1
    v_add_u32 v61, s99, v61
    buffer_store_dword v60, v61, s[20:23], 0 offen sc1
    buffer_load_dword v22, v20, s[20:23], 0 offen offset:0 sc1
    buffer_load_dword v23, v20, s[20:23], 0 offen offset:128 sc1
    buffer_load_dwordx4 v[128:131], v9, s[20:23], s54 offen offset:0 sc1
    buffer_load_dwordx4 v[132:135], v9, s[20:23], s54 offen offset:1024 sc1
    buffer_load_dwordx4 v[136:139], v9, s[20:23], s54 offen offset:2048 sc1
    buffer_load_dwordx4 v[140:143], v9, s[20:23], s54 offen offset:3072 sc1
    buffer_load_dwordx4 v[144:147], v9, s[20:23], s55 offen offset:0 sc1
    buffer_load_dwordx4 v[148:151], v9, s[20:23], s55 offen offset:1024 sc1
    buffer_load_dwordx4 v[152:155], v9, s[20:23], s55 offen offset:2048 sc1
    buffer_load_dwordx4 v[156:159], v9, s[20:23], s55 offen offset:3072 sc1
    buffer_load_dwordx4 v[160:163], v9, s[20:23], s56 offen offset:0 sc1
    buffer_load_dwordx4 v[164:167], v9, s[20:23], s56 offen offset:1024 sc1
    buffer_load_dwordx4 v[168:171], v9, s[20:23], s56 offen offset:2048 sc1
    buffer_load_dwordx4 v[172:175], v9, s[20:23], s56 offen offset:3072 sc1
    s_add_u32 m0, s62, 0x1c000
    s_nop 0
    buffer_load_dwordx4 v26, s[32:35], s44 offen offset:0 lds
    buffer_load_dwordx4 v27, s[32:35], s44 offen offset:1024 lds
    buffer_load_dwordx4 v28, s[32:35], s44 offen offset:2048 lds
    buffer_load_dwordx4 v29, s[32:35], s44 offen offset:3072 lds
    s_add_u32 m0, s62, 0x20000
    s_nop 0
    buffer_load_dwordx4 v26, s[32:35], s45 offen offset:0 lds
    buffer_load_dwordx4 v27, s[32:35], s45 offen offset:1024 lds
    buffer_load_dwordx4 v28, s[32:35], s45 offen offset:2048 lds
    buffer_load_dwordx4 v29, s[32:35], s45 offen offset:3072 lds
    s_add_u32 m0, s62, 0x24000
    s_nop 0
    buffer_load_dwordx4 v26, s[32:35], s46 offen offset:0 lds
    buffer_load_dwordx4 v27, s[32:35], s46 offen offset:1024 lds
    buffer_load_dwordx4 v28, s[32:35], s46 offen offset:2048 lds
    buffer_load_dwordx4 v29, s[32:35], s46 offen offset:3072 lds
    s_waitcnt vmcnt(24)
    s_cmp_lg_u32 s70, 0
    s_cselect_b32 s76, s63, 0
    v_add_u32 v2, s76, v14
    v_lshrrev_b32 v8, 5, v1
    v_lshlrev_b32 v8, 2, v8
    s_lshl_b32 s77, s3, 4
    v_add_u32 v8, s77, v8
    s_lshl_b32 s76, s63, 31
    s_mov_b32 s77, 0x3c800000
    v_xor_b32 v21, s76, v22
    v_add_u32 v3, 0, v8
    v_mul_u32_u24 v3, v3, v2
    v_and_b32 v3, 63, v3
    v_cvt_f32_u32 v3, v3
    v_mul_f32 v3, s77, v3
    v_cos_f32 v5, v3
    v_sin_f32 v6, v3
    s_nop 0
    v_mul_f32 v5, v5, v22
    v_mul_f32 v6, v6, v21
    v_cvt_pk_bf16_f32 v44, v5, v6
    v_add_u32 v3, 1, v8
    v_mul_u32_u24 v3, v3, v2
    v_and_b32 v3, 63, v3
    v_cvt_f32_u32 v3, v3
    v_mul_f32 v3, s77, v3
    v_cos_f32 v5, v3
    v_sin_f32 v6, v3
    s_nop 0
    v_mul_f32 v5, v5, v22
    v_mul_f32 v6, v6, v21
    v_cvt_pk_bf16_f32 v45, v5, v6
    v_add_u32 v3, 2, v8
    v_mul_u32_u24 v3, v3, v2
    v_and_b32 v3, 63, v3
    v_cvt_f32_u32 v3, v3
    v_mul_f32 v3, s77, v3
    v_cos_f32 v5, v3
    v_sin_f32 v6, v3
    s_nop 0
    v_mul_f32 v5, v5, v22
    v_mul_f32 v6, v6, v21
    v_cvt_pk_bf16_f32 v46, v5, v6
    v_add_u32 v3, 3, v8
    v_mul_u32_u24 v3, v3, v2
    v_and_b32 v3, 63, v3
    v_cvt_f32_u32 v3, v3
    v_mul_f32 v3, s77, v3
    v_cos_f32 v5, v3
    v_sin_f32 v6, v3
    s_nop 0
    v_mul_f32 v5, v5, v22
    v_mul_f32 v6, v6, v21
    v_cvt_pk_bf16_f32 v47, v5, v6
    v_add_u32 v3, 8, v8
    v_mul_u32_u24 v3, v3, v2
    v_and_b32 v3, 63, v3
    v_cvt_f32_u32 v3, v3
    v_mul_f32 v3, s77, v3
    v_cos_f32 v5, v3
    v_sin_f32 v6, v3
    s_nop 0
    v_mul_f32 v5, v5, v22
    v_mul_f32 v6, v6, v21
    v_cvt_pk_bf16_f32 v48, v5, v6
    v_add_u32 v3, 9, v8
    v_mul_u32_u24 v3, v3, v2
    v_and_b32 v3, 63, v3
    v_cvt_f32_u32 v3, v3
    v_mul_f32 v3, s77, v3
    v_cos_f32 v5, v3
    v_sin_f32 v6, v3
    s_nop 0
    v_mul_f32 v5, v5, v22
    v_mul_f32 v6, v6, v21
    v_cvt_pk_bf16_f32 v49, v5, v6
    v_add_u32 v3, 10, v8
    v_mul_u32_u24 v3, v3, v2
    v_and_b32 v3, 63, v3
    v_cvt_f32_u32 v3, v3
    v_mul_f32 v3, s77, v3
    v_cos_f32 v5, v3
    v_sin_f32 v6, v3
    s_nop 0
    v_mul_f32 v5, v5, v22
    v_mul_f32 v6, v6, v21
    v_cvt_pk_bf16_f32 v50, v5, v6
    v_add_u32 v3, 11, v8
    v_mul_u32_u24 v3, v3, v2
    v_and_b32 v3, 63, v3
    v_cvt_f32_u32 v3, v3
    v_mul_f32 v3, s77, v3
    v_cos_f32 v5, v3
    v_sin_f32 v6, v3
    s_nop 0
    v_mul_f32 v5, v5, v22
    v_mul_f32 v6, v6, v21
    v_cvt_pk_bf16_f32 v51, v5, v6
    v_add_u32 v2, 32, v2
    v_xor_b32 v21, s76, v23
    v_add_u32 v3, 0, v8
    v_mul_u32_u24 v3, v3, v2
    v_and_b32 v3, 63, v3
    v_cvt_f32_u32 v3, v3
    v_mul_f32 v3, s77, v3
    v_cos_f32 v5, v3
    v_sin_f32 v6, v3
    s_nop 0
    v_mul_f32 v5, v5, v23
    v_mul_f32 v6, v6, v21
    v_cvt_pk_bf16_f32 v52, v5, v6
    v_add_u32 v3, 1, v8
    v_mul_u32_u24 v3, v3, v2
    v_and_b32 v3, 63, v3
    v_cvt_f32_u32 v3, v3
    v_mul_f32 v3, s77, v3
    v_cos_f32 v5, v3
    v_sin_f32 v6, v3
    s_nop 0
    v_mul_f32 v5, v5, v23
    v_mul_f32 v6, v6, v21
    v_cvt_pk_bf16_f32 v53, v5, v6
    v_add_u32 v3, 2, v8
    v_mul_u32_u24 v3, v3, v2
    v_and_b32 v3, 63, v3
    v_cvt_f32_u32 v3, v3
    v_mul_f32 v3, s77, v3
    v_cos_f32 v5, v3
    v_sin_f32 v6, v3
    s_nop 0
    v_mul_f32 v5, v5, v23
    v_mul_f32 v6, v6, v21
    v_cvt_pk_bf16_f32 v54, v5, v6
    v_add_u32 v3, 3, v8
    v_mul_u32_u24 v3, v3, v2
    v_and_b32 v3, 63, v3
    v_cvt_f32_u32 v3, v3
    v_mul_f32 v3, s77, v3
    v_cos_f32 v5, v3
    v_sin_f32 v6, v3
    s_nop 0
    v_mul_f32 v5, v5, v23
    v_mul_f32 v6, v6, v21
    v_cvt_pk_bf16_f32 v55, v5, v6
    v_add_u32 v3, 8, v8
    v_mul_u32_u24 v3, v3, v2
    v_and_b32 v3, 63, v3
    v_cvt_f32_u32 v3, v3
    v_mul_f32 v3, s77, v3
    v_cos_f32 v5, v3
    v_sin_f32 v6, v3
    s_nop 0
    v_mul_f32 v5, v5, v23
    v_mul_f32 v6, v6, v21
    v_cvt_pk_bf16_f32 v56, v5, v6
    v_add_u32 v3, 9, v8
    v_mul_u32_u24 v3, v3, v2
    v_and_b32 v3, 63, v3
    v_cvt_f32_u32 v3, v3
    v_mul_f32 v3, s77, v3
    v_cos_f32 v5, v3
    v_sin_f32 v6, v3
    s_nop 0
    v_mul_f32 v5, v5, v23
    v_mul_f32 v6, v6, v21
    v_cvt_pk_bf16_f32 v57, v5, v6
    v_add_u32 v3, 10, v8
    v_mul_u32_u24 v3, v3, v2
    v_and_b32 v3, 63, v3
    v_cvt_f32_u32 v3, v3
    v_mul_f32 v3, s77, v3
    v_cos_f32 v5, v3
    v_sin_f32 v6, v3
    s_nop 0
    v_mul_f32 v5, v5, v23
    v_mul_f32 v6, v6, v21
    v_cvt_pk_bf16_f32 v58, v5, v6
    v_add_u32 v3, 11, v8
    v_mul_u32_u24 v3, v3, v2
    v_and_b32 v3, 63, v3
    v_cvt_f32_u32 v3, v3
    v_mul_f32 v3, s77, v3
    v_cos_f32 v5, v3
    v_sin_f32 v6, v3
    s_nop 0
    v_mul_f32 v5, v5, v23
    v_mul_f32 v6, v6, v21
    v_cvt_pk_bf16_f32 v59, v5, v6
    v_sub_f32 v40, 1.0, v22
    v_mov_b32 v41, v40
    v_sub_f32 v42, 1.0, v23
    v_mov_b32 v43, v42
    ds_read_b64_tr_b16 v[240:241], v11 offset:49152
    ds_read_b64_tr_b16 v[242:243], v11 offset:50176
    ds_read_b64_tr_b16 v[244:245], v12 offset:49152
    ds_read_b64_tr_b16 v[246:247], v12 offset:50176
    ds_read_b64_tr_b16 v[248:249], v11 offset:51200
    ds_read_b64_tr_b16 v[250:251], v11 offset:52224
    ds_read_b64_tr_b16 v[252:253], v12 offset:51200
    ds_read_b64_tr_b16 v[254:255], v12 offset:52224
    s_waitcnt vmcnt(22)
    s_waitcnt lgkmcnt(6)
    v_mfma_f32_32x32x16_bf16 v[64:79], v[240:243], v[128:131], 0
    v_mfma_f32_32x32x16_bf16 v[80:95], v[240:243], v[132:135], 0
    s_waitcnt lgkmcnt(4)
    v_mfma_f32_32x32x16_bf16 v[96:111], v[244:247], v[128:131], 0
    v_mfma_f32_32x32x16_bf16 v[112:127], v[244:247], v[132:135], 0
    ds_read_b64_tr_b16 v[240:241], v18 offset:0
    ds_read_b64_tr_b16 v[242:243], v18 offset:1024
    ds_read_b64_tr_b16 v[244:245], v19 offset:0
    ds_read_b64_tr_b16 v[246:247], v19 offset:1024
    s_waitcnt vmcnt(20)
    s_waitcnt lgkmcnt(6)
    v_mfma_f32_32x32x16_bf16 v[64:79], v[248:251], v[136:139], v[64:79]
    v_mfma_f32_32x32x16_bf16 v[80:95], v[248:251], v[140:143], v[80:95]
    s_waitcnt lgkmcnt(4)
    v_mfma_f32_32x32x16_bf16 v[96:111], v[252:255], v[136:139], v[96:111]
    v_mfma_f32_32x32x16_bf16 v[112:127], v[252:255], v[140:143], v[112:127]
    s_add_u32 m0, s62, 0xc000
    s_nop 0
    buffer_load_dwordx4 v26, s[32:35], s47 offen offset:0 lds
    buffer_load_dwordx4 v27, s[32:35], s47 offen offset:1024 lds
    buffer_load_dwordx4 v28, s[32:35], s47 offen offset:2048 lds
    buffer_load_dwordx4 v29, s[32:35], s47 offen offset:3072 lds
    ds_read_b64_tr_b16 v[248:249], v18 offset:2048
    ds_read_b64_tr_b16 v[250:251], v18 offset:3072
    ds_read_b64_tr_b16 v[252:253], v19 offset:2048
    ds_read_b64_tr_b16 v[254:255], v19 offset:3072
    s_waitcnt vmcnt(22)
    s_waitcnt lgkmcnt(6)
    v_mfma_f32_32x32x16_bf16 v[64:79], v[240:243], v[144:147], v[64:79]
    v_mfma_f32_32x32x16_bf16 v[80:95], v[240:243], v[148:151], v[80:95]
    s_waitcnt lgkmcnt(4)
    v_mfma_f32_32x32x16_bf16 v[96:111], v[244:247], v[144:147], v[96:111]
    v_mfma_f32_32x32x16_bf16 v[112:127], v[244:247], v[148:151], v[112:127]
    ds_read_b64_tr_b16 v[240:241], v18 offset:16384
    ds_read_b64_tr_b16 v[242:243], v18 offset:17408
    ds_read_b64_tr_b16 v[244:245], v19 offset:16384
    ds_read_b64_tr_b16 v[246:247], v19 offset:17408
    s_waitcnt vmcnt(20)
    s_waitcnt lgkmcnt(6)
    v_mfma_f32_32x32x16_bf16 v[64:79], v[248:251], v[152:155], v[64:79]
    v_mfma_f32_32x32x16_bf16 v[80:95], v[248:251], v[156:159], v[80:95]
    s_waitcnt lgkmcnt(4)
    v_mfma_f32_32x32x16_bf16 v[96:111], v[252:255], v[152:155], v[96:111]
    v_mfma_f32_32x32x16_bf16 v[112:127], v[252:255], v[156:159], v[112:127]
    s_add_u32 m0, s62, 0x10000
    s_nop 0
    buffer_load_dwordx4 v26, s[32:35], s48 offen offset:0 lds
    buffer_load_dwordx4 v27, s[32:35], s48 offen offset:1024 lds
    buffer_load_dwordx4 v28, s[32:35], s48 offen offset:2048 lds
    buffer_load_dwordx4 v29, s[32:35], s48 offen offset:3072 lds
    ds_read_b64_tr_b16 v[248:249], v18 offset:18432
    ds_read_b64_tr_b16 v[250:251], v18 offset:19456
    ds_read_b64_tr_b16 v[252:253], v19 offset:18432
    ds_read_b64_tr_b16 v[254:255], v19 offset:19456
    s_waitcnt vmcnt(22)
    s_waitcnt lgkmcnt(6)
    v_mfma_f32_32x32x16_bf16 v[64:79], v[240:243], v[160:163], v[64:79]
    v_mfma_f32_32x32x16_bf16 v[80:95], v[240:243], v[164:167], v[80:95]
    s_waitcnt lgkmcnt(4)
    v_mfma_f32_32x32x16_bf16 v[96:111], v[244:247], v[160:163], v[96:111]
    v_mfma_f32_32x32x16_bf16 v[112:127], v[244:247], v[164:167], v[112:127]
    s_waitcnt vmcnt(20)
    s_waitcnt lgkmcnt(2)
    v_mfma_f32_32x32x16_bf16 v[64:79], v[248:251], v[168:171], v[64:79]
    v_mfma_f32_32x32x16_bf16 v[80:95], v[248:251], v[172:175], v[80:95]
    s_waitcnt lgkmcnt(0)
    v_mfma_f32_32x32x16_bf16 v[96:111], v[252:255], v[168:171], v[96:111]
    v_mfma_f32_32x32x16_bf16 v[112:127], v[252:255], v[172:175], v[112:127]
    s_add_u32 m0, s62, 0x14000
    s_nop 0
    buffer_load_dwordx4 v26, s[32:35], s49 offen offset:0 lds
    buffer_load_dwordx4 v27, s[32:35], s49 offen offset:1024 lds
    buffer_load_dwordx4 v28, s[32:35], s49 offen offset:2048 lds
    buffer_load_dwordx4 v29, s[32:35], s49 offen offset:3072 lds
    s_lshr_b32 s43, s70, 1
    s_lshl_b32 s43, s43, 9
    s_add_u32 s100, s43, 0x910100
    v_lshlrev_b32 v61, 2, v1
    v_add_u32 v61, s100, v61
    v_cmp_gt_u32 vcc, 56, v1
    v_mov_b32 v60, 0x7fffffff
    s_nop 0
    v_cndmask_b32 v61, v60, v61, vcc
    s_mov_b32 s41, 0
POLL_14:
    buffer_load_dword v60, v61, s[20:23], 0 offen sc1
    s_waitcnt vmcnt(0)
    v_cmp_eq_u32 vcc, s98, v60
    s_nop 1
    s_and_b32 s43, vcc_hi, 0xffffff
    s_cmp_eq_u32 s43, 0xffffff
    s_cselect_b32 s42, vcc_lo, 0
    s_cmp_eq_u32 s42, -1
    s_cbranch_scc1 POLLD_15
    s_add_u32 s41, s41, 1
    s_cmp_ge_u32 s41, 0x40000
    s_cbranch_scc1 POLLD_15
    s_branch POLL_14
POLLD_15:
    v_lshlrev_b32 v62, 2, v1
    v_add_u32 v62, 0x912000, v62
    v_mov_b32 v60, 0x7fffffff
    v_cmp_gt_u32 vcc, 32, v1
    s_nop 1
    v_cndmask_b32 v62, v60, v62, vcc
    buffer_load_dwordx4 v[128:131], v13, s[20:23], s51 offen offset:0 sc1
    buffer_load_dwordx4 v[132:135], v13, s[20:23], s51 offen offset:1024 sc1
    buffer_load_dwordx4 v[136:139], v13, s[20:23], s51 offen offset:2048 sc1
    buffer_load_dwordx4 v[140:143], v13, s[20:23], s51 offen offset:3072 sc1
    buffer_load_dwordx4 v[144:147], v13, s[20:23], s52 offen offset:0 sc1
    buffer_load_dwordx4 v[148:151], v13, s[20:23], s52 offen offset:1024 sc1
    buffer_load_dwordx4 v[152:155], v13, s[20:23], s52 offen offset:2048 sc1
    buffer_load_dwordx4 v[156:159], v13, s[20:23], s52 offen offset:3072 sc1
    buffer_load_dwordx4 v[160:163], v13, s[20:23], s53 offen offset:0 sc1
    buffer_load_dwordx4 v[164:167], v13, s[20:23], s53 offen offset:1024 sc1
    ds_read_b64_tr_b16 v[240:241], v18 offset:49152
    ds_read_b64_tr_b16 v[242:243], v18 offset:50176
    ds_read_b64_tr_b16 v[244:245], v19 offset:49152
    ds_read_b64_tr_b16 v[246:247], v19 offset:50176
    buffer_load_dwordx4 v[168:171], v13, s[20:23], s53 offen offset:2048 sc1
    buffer_load_dwordx4 v[172:175], v13, s[20:23], s53 offen offset:3072 sc1
    ds_read_b64_tr_b16 v[248:249], v18 offset:51200
    ds_read_b64_tr_b16 v[250:251], v18 offset:52224
    ds_read_b64_tr_b16 v[252:253], v19 offset:51200
    ds_read_b64_tr_b16 v[254:255], v19 offset:52224
    s_waitcnt vmcnt(10)
    s_waitcnt lgkmcnt(6)
    v_mfma_f32_32x32x16_bf16 v[64:79], v[240:243], v[128:131], v[64:79]
    v_mfma_f32_32x32x16_bf16 v[80:95], v[240:243], v[132:135], v[80:95]
    s_waitcnt lgkmcnt(4)
    v_mfma_f32_32x32x16_bf16 v[96:111], v[244:247], v[128:131], v[96:111]
    v_mfma_f32_32x32x16_bf16 v[112:127], v[244:247], v[132:135], v[112:127]
    buffer_load_dwordx4 v[176:179], v13, s[20:23], s54 offen offset:0 sc1
    buffer_load_dwordx4 v[180:183], v13, s[20:23], s54 offen offset:1024 sc1
    ds_read_b64_tr_b16 v[240:241], v15 offset:0
    ds_read_b64_tr_b16 v[242:243], v15 offset:1024
    ds_read_b64_tr_b16 v[244:245], v63 offset:0
    ds_read_b64_tr_b16 v[246:247], v63 offset:1024
    s_waitcnt vmcnt(10)
    s_waitcnt lgkmcnt(6)
    v_mfma_f32_32x32x16_bf16 v[64:79], v[248:251], v[136:139], v[64:79]
    v_mfma_f32_32x32x16_bf16 v[80:95], v[248:251], v[140:143], v[80:95]
    s_waitcnt lgkmcnt(4)
    v_mfma_f32_32x32x16_bf16 v[96:111], v[252:255], v[136:139], v[96:111]
    v_mfma_f32_32x32x16_bf16 v[112:127], v[252:255], v[140:143], v[112:127]
    buffer_load_dwordx4 v[184:187], v13, s[20:23], s54 offen offset:2048 sc1
    buffer_load_dwordx4 v[188:191], v13, s[20:23], s54 offen offset:3072 sc1
    ds_read_b64_tr_b16 v[248:249], v15 offset:2048
    ds_read_b64_tr_b16 v[250:251], v15 offset:3072
    ds_read_b64_tr_b16 v[252:253], v63 offset:2048
    ds_read_b64_tr_b16 v[254:255], v63 offset:3072
    s_waitcnt vmcnt(10)
    s_waitcnt lgkmcnt(6)
    v_mfma_f32_32x32x16_bf16 v[64:79], v[240:243], v[144:147], v[64:79]
    v_mfma_f32_32x32x16_bf16 v[80:95], v[240:243], v[148:151], v[80:95]
    s_waitcnt lgkmcnt(4)
    v_mfma_f32_32x32x16_bf16 v[96:111], v[244:247], v[144:147], v[96:111]
    v_mfma_f32_32x32x16_bf16 v[112:127], v[244:247], v[148:151], v[112:127]
    buffer_load_dwordx4 v[192:195], v13, s[20:23], s55 offen offset:0 sc1
    buffer_load_dwordx4 v[196:199], v13, s[20:23], s55 offen offset:1024 sc1
    s_waitcnt vmcnt(10)
    s_waitcnt lgkmcnt(2)
    v_mfma_f32_32x32x16_bf16 v[64:79], v[248:251], v[152:155], v[64:79]
    v_mfma_f32_32x32x16_bf16 v[80:95], v[248:251], v[156:159], v[80:95]
    s_waitcnt lgkmcnt(0)
    v_mfma_f32_32x32x16_bf16 v[96:111], v[252:255], v[152:155], v[96:111]
    v_mfma_f32_32x32x16_bf16 v[112:127], v[252:255], v[156:159], v[112:127]
    s_barrier
    ds_read_b64_tr_b16 v[240:241], v15 offset:16384
    ds_read_b64_tr_b16 v[242:243], v15 offset:17408
    ds_read_b64_tr_b16 v[244:245], v63 offset:16384
    ds_read_b64_tr_b16 v[246:247], v63 offset:17408
    buffer_load_dwordx4 v[200:203], v13, s[20:23], s55 offen offset:2048 sc1
    buffer_load_dwordx4 v[204:207], v13, s[20:23], s55 offen offset:3072 sc1
    ds_read_b64_tr_b16 v[248:249], v15 offset:18432
    ds_read_b64_tr_b16 v[250:251], v15 offset:19456
    ds_read_b64_tr_b16 v[252:253], v63 offset:18432
    ds_read_b64_tr_b16 v[254:255], v63 offset:19456
    s_waitcnt vmcnt(10)
    s_waitcnt lgkmcnt(6)
    v_mfma_f32_32x32x16_bf16 v[64:79], v[240:243], v[160:163], v[64:79]
    v_mfma_f32_32x32x16_bf16 v[80:95], v[240:243], v[164:167], v[80:95]
    s_waitcnt lgkmcnt(4)
    v_mfma_f32_32x32x16_bf16 v[96:111], v[244:247], v[160:163], v[96:111]
    v_mfma_f32_32x32x16_bf16 v[112:127], v[244:247], v[164:167], v[112:127]
    buffer_load_dwordx4 v[208:211], v13, s[20:23], s56 offen offset:0 sc1
    buffer_load_dwordx4 v[212:215], v13, s[20:23], s56 offen offset:1024 sc1
    ds_read_b64_tr_b16 v[240:241], v11 offset:49152
    ds_read_b64_tr_b16 v[242:243], v11 offset:50176
    ds_read_b64_tr_b16 v[244:245], v12 offset:49152
    ds_read_b64_tr_b16 v[246:247], v12 offset:50176
    s_waitcnt vmcnt(10)
    s_waitcnt lgkmcnt(6)
    v_mfma_f32_32x32x16_bf16 v[64:79], v[248:251], v[168:171], v[64:79]
    v_mfma_f32_32x32x16_bf16 v[80:95], v[248:251], v[172:175], v[80:95]
    s_waitcnt lgkmcnt(4)
    v_mfma_f32_32x32x16_bf16 v[96:111], v[252:255], v[168:171], v[96:111]
    v_mfma_f32_32x32x16_bf16 v[112:127], v[252:255], v[172:175], v[112:127]
    buffer_load_dwordx4 v[216:219], v13, s[20:23], s56 offen offset:2048 sc1
    buffer_load_dwordx4 v[220:223], v13, s[20:23], s56 offen offset:3072 sc1
    ds_read_b64_tr_b16 v[248:249], v11 offset:51200
    ds_read_b64_tr_b16 v[250:251], v11 offset:52224
    ds_read_b64_tr_b16 v[252:253], v12 offset:51200
    ds_read_b64_tr_b16 v[254:255], v12 offset:52224
    s_waitcnt vmcnt(10)
    s_waitcnt lgkmcnt(6)
    v_mfma_f32_32x32x16_bf16 v[64:79], v[240:243], v[176:179], v[64:79]
    v_mfma_f32_32x32x16_bf16 v[80:95], v[240:243], v[180:183], v[80:95]
    s_waitcnt lgkmcnt(4)
    v_mfma_f32_32x32x16_bf16 v[96:111], v[244:247], v[176:179], v[96:111]
    v_mfma_f32_32x32x16_bf16 v[112:127], v[244:247], v[180:183], v[112:127]
    buffer_load_dwordx4 v[224:227], v13, s[20:23], s57 offen offset:0 sc1
    buffer_load_dwordx4 v[228:231], v13, s[20:23], s57 offen offset:1024 sc1
    ds_read_b64_tr_b16 v[240:241], v18 offset:0
    ds_read_b64_tr_b16 v[242:243], v18 offset:1024
    ds_read_b64_tr_b16 v[244:245], v19 offset:0
    ds_read_b64_tr_b16 v[246:247], v19 offset:1024
    s_waitcnt vmcnt(10)
    s_waitcnt lgkmcnt(6)
    v_mfma_f32_32x32x16_bf16 v[64:79], v[248:251], v[184:187], v[64:79]
    v_mfma_f32_32x32x16_bf16 v[80:95], v[248:251], v[188:191], v[80:95]
    s_waitcnt lgkmcnt(4)
    v_mfma_f32_32x32x16_bf16 v[96:111], v[252:255], v[184:187], v[96:111]
    v_mfma_f32_32x32x16_bf16 v[112:127], v[252:255], v[188:191], v[112:127]
    buffer_load_dwordx4 v[232:235], v13, s[20:23], s57 offen offset:2048 sc1
    buffer_load_dwordx4 v[236:239], v13, s[20:23], s57 offen offset:3072 sc1
    buffer_load_dword v10, v62, s[20:23], 0 offen sc1
    ds_read_b64_tr_b16 v[248:249], v18 offset:2048
    ds_read_b64_tr_b16 v[250:251], v18 offset:3072
    ds_read_b64_tr_b16 v[252:253], v19 offset:2048
    ds_read_b64_tr_b16 v[254:255], v19 offset:3072
    s_waitcnt vmcnt(11)
    s_waitcnt lgkmcnt(6)
    v_mfma_f32_32x32x16_bf16 v[64:79], v[240:243], v[192:195], v[64:79]
    v_mfma_f32_32x32x16_bf16 v[80:95], v[240:243], v[196:199], v[80:95]
    s_waitcnt lgkmcnt(4)
    v_mfma_f32_32x32x16_bf16 v[96:111], v[244:247], v[192:195], v[96:111]
    v_mfma_f32_32x32x16_bf16 v[112:127], v[244:247], v[196:199], v[112:127]
    ds_read_b64_tr_b16 v[240:241], v18 offset:16384
    ds_read_b64_tr_b16 v[242:243], v18 offset:17408
    ds_read_b64_tr_b16 v[244:245], v19 offset:16384
    ds_read_b64_tr_b16 v[246:247], v19 offset:17408
    s_waitcnt vmcnt(9)
    s_waitcnt lgkmcnt(6)
    v_mfma_f32_32x32x16_bf16 v[64:79], v[248:251], v[200:203], v[64:79]
    v_mfma_f32_32x32x16_bf16 v[80:95], v[248:251], v[204:207], v[80:95]
    s_waitcnt lgkmcnt(4)
    v_mfma_f32_32x32x16_bf16 v[96:111], v[252:255], v[200:203], v[96:111]
    v_mfma_f32_32x32x16_bf16 v[112:127], v[252:255], v[204:207], v[112:127]
    ds_read_b64_tr_b16 v[248:249], v18 offset:18432
    ds_read_b64_tr_b16 v[250:251], v18 offset:19456
    ds_read_b64_tr_b16 v[252:253], v19 offset:18432
    ds_read_b64_tr_b16 v[254:255], v19 offset:19456
    s_waitcnt vmcnt(7)
    s_waitcnt lgkmcnt(6)
    v_mfma_f32_32x32x16_bf16 v[64:79], v[240:243], v[208:211], v[64:79]
    v_mfma_f32_32x32x16_bf16 v[80:95], v[240:243], v[212:215], v[80:95]
    s_waitcnt lgkmcnt(4)
    v_mfma_f32_32x32x16_bf16 v[96:111], v[244:247], v[208:211], v[96:111]
    v_mfma_f32_32x32x16_bf16 v[112:127], v[244:247], v[212:215], v[112:127]
    ds_read_b64_tr_b16 v[240:241], v11 offset:0
    ds_read_b64_tr_b16 v[242:243], v11 offset:1024
    ds_read_b64_tr_b16 v[244:245], v12 offset:0
    ds_read_b64_tr_b16 v[246:247], v12 offset:1024
    s_waitcnt vmcnt(5)
    s_waitcnt lgkmcnt(6)
    v_mfma_f32_32x32x16_bf16 v[64:79], v[248:251], v[216:219], v[64:79]
    v_mfma_f32_32x32x16_bf16 v[80:95], v[248:251], v[220:223], v[80:95]
    s_waitcnt lgkmcnt(4)
    v_mfma_f32_32x32x16_bf16 v[96:111], v[252:255], v[216:219], v[96:111]
    v_mfma_f32_32x32x16_bf16 v[112:127], v[252:255], v[220:223], v[112:127]
    s_waitcnt vmcnt(0)
    s_mov_b32 s41, 0
DSP_17:
    v_cmp_eq_u32 vcc, s98, v10
    s_nop 1
    s_cmp_eq_u32 vcc_lo, -1
    s_cbranch_scc1 DOK_16
    s_add_u32 s41, s41, 1
    s_cmp_ge_u32 s41, 0x40000
    s_cbranch_scc1 DOK_16
    buffer_load_dword v10, v62, s[20:23], 0 offen sc1
    s_waitcnt vmcnt(0)
    s_branch DSP_17
DOK_16:
    s_add_u32 s68, s65, 0
    buffer_load_dwordx4 v[128:131], v16, s[20:23], s68 offen sc1
    s_add_u32 s68, s65, 0
    buffer_load_dwordx4 v[132:135], v17, s[20:23], s68 offen sc1
    s_add_u32 s68, s65, 8192
    buffer_load_dwordx4 v[136:139], v16, s[20:23], s68 offen sc1
    s_add_u32 s68, s65, 8192
    buffer_load_dwordx4 v[140:143], v17, s[20:23], s68 offen sc1
    ds_read_b64_tr_b16 v[248:249], v11 offset:2048
    ds_read_b64_tr_b16 v[250:251], v11 offset:3072
    ds_read_b64_tr_b16 v[252:253], v12 offset:2048
    ds_read_b64_tr_b16 v[254:255], v12 offset:3072
    s_waitcnt lgkmcnt(6)
    v_mfma_f32_32x32x16_bf16 v[64:79], v[240:243], v[224:227], v[64:79]
    v_mfma_f32_32x32x16_bf16 v[80:95], v[240:243], v[228:231], v[80:95]
    s_waitcnt lgkmcnt(4)
    v_mfma_f32_32x32x16_bf16 v[96:111], v[244:247], v[224:227], v[96:111]
    v_mfma_f32_32x32x16_bf16 v[112:127], v[244:247], v[228:231], v[112:127]
    s_waitcnt lgkmcnt(2)
    v_mfma_f32_32x32x16_bf16 v[64:79], v[248:251], v[232:235], v[64:79]
    v_mfma_f32_32x32x16_bf16 v[80:95], v[248:251], v[236:239], v[80:95]
    s_waitcnt lgkmcnt(0)
    v_mfma_f32_32x32x16_bf16 v[96:111], v[252:255], v[232:235], v[96:111]
    v_mfma_f32_32x32x16_bf16 v[112:127], v[252:255], v[236:239], v[112:127]
    s_nop 7
    s_nop 3
    v_pk_mul_f32 v[64:65], v[64:65], v[40:41]
    v_pk_mul_f32 v[66:67], v[66:67], v[40:41]
    v_pk_mul_f32 v[68:69], v[68:69], v[40:41]
    v_pk_mul_f32 v[70:71], v[70:71], v[40:41]
    v_pk_mul_f32 v[72:73], v[72:73], v[40:41]
    v_pk_mul_f32 v[74:75], v[74:75], v[40:41]
    v_pk_mul_f32 v[76:77], v[76:77], v[40:41]
    v_pk_mul_f32 v[78:79], v[78:79], v[40:41]
    v_pk_mul_f32 v[80:81], v[80:81], v[42:43]
    v_pk_mul_f32 v[82:83], v[82:83], v[42:43]
    v_pk_mul_f32 v[84:85], v[84:85], v[42:43]
    v_pk_mul_f32 v[86:87], v[86:87], v[42:43]
    v_pk_mul_f32 v[88:89], v[88:89], v[42:43]
    v_pk_mul_f32 v[90:91], v[90:91], v[42:43]
    v_pk_mul_f32 v[92:93], v[92:93], v[42:43]
    v_pk_mul_f32 v[94:95], v[94:95], v[42:43]
    v_pk_mul_f32 v[96:97], v[96:97], v[40:41]
    v_pk_mul_f32 v[98:99], v[98:99], v[40:41]
    v_pk_mul_f32 v[100:101], v[100:101], v[40:41]
    v_pk_mul_f32 v[102:103], v[102:103], v[40:41]
    v_pk_mul_f32 v[104:105], v[104:105], v[40:41]
    v_pk_mul_f32 v[106:107], v[106:107], v[40:41]
    v_pk_mul_f32 v[108:109], v[108:109], v[40:41]
    v_pk_mul_f32 v[110:111], v[110:111], v[40:41]
    v_pk_mul_f32 v[112:113], v[112:113], v[42:43]
    v_pk_mul_f32 v[114:115], v[114:115], v[42:43]
    v_pk_mul_f32 v[116:117], v[116:117], v[42:43]
    v_pk_mul_f32 v[118:119], v[118:119], v[42:43]
    v_pk_mul_f32 v[120:121], v[120:121], v[42:43]
    v_pk_mul_f32 v[122:123], v[122:123], v[42:43]
    v_pk_mul_f32 v[124:125], v[124:125], v[42:43]
    v_pk_mul_f32 v[126:127], v[126:127], v[42:43]
    s_waitcnt vmcnt(0)
    s_nop 1
    v_mfma_f32_32x32x16_bf16 v[64:79], v[128:131], v[44:47], v[64:79]
    v_mfma_f32_32x32x16_bf16 v[80:95], v[128:131], v[52:55], v[80:95]
    v_mfma_f32_32x32x16_bf16 v[96:111], v[132:135], v[44:47], v[96:111]
    v_mfma_f32_32x32x16_bf16 v[112:127], v[132:135], v[52:55], v[112:127]
    v_mfma_f32_32x32x16_bf16 v[64:79], v[136:139], v[48:51], v[64:79]
    v_mfma_f32_32x32x16_bf16 v[80:95], v[136:139], v[56:59], v[80:95]
    v_mfma_f32_32x32x16_bf16 v[96:111], v[140:143], v[48:51], v[96:111]
    v_mfma_f32_32x32x16_bf16 v[112:127], v[140:143], v[56:59], v[112:127]
    v_lshlrev_b32 v2, 4, v1
    s_add_u32 s41, s3, 2
    s_cmp_eq_u32 s3, 0
    s_cselect_b32 s41, 0, s41
    s_lshl_b32 s41, s41, 14
    v_add_u32 v3, s41, v2
    s_add_u32 s41, s3, 1
    s_lshl_b32 s41, s41, 14
    s_cmp_eq_u32 s3, 2
    s_cselect_b32 s41, 98304, s41
    s_cmp_eq_u32 s3, 3
    s_cselect_b32 s41, 0x1c000, s41
    v_add_u32 v5, s41, v2
    s_lshl_b32 s41, s3, 12
    v_add_u32 v6, s41, v2
    v_add_u32 v7, 0x10000, v6
    s_and_b32 s41, s3, 1
    s_cmp_eq_u32 s41, 1
    s_cselect_b64 vcc, -1, 0
    s_lshl_b32 s41, s41, 5
    v_add_u32 v8, s41, v14
    v_cndmask_b32 v40, v40, v42, vcc
    v_mov_b32 v41, v40
    v_lshlrev_b32 v8, 5, v8
    v_add_u32 v8, s70, v8
    s_movk_i32 s42, 896
    v_mul_lo_u32 v8, v8, s42
    s_lshl_b32 s41, s71, 7
    s_lshr_b32 s42, s3, 1
    s_lshl_b32 s42, s42, 6
    s_add_u32 s41, s41, s42
    v_lshrrev_b32 v9, 5, v1
    v_lshlrev_b32 v9, 4, v9
    v_add3_u32 v8, v8, v9, s41
    s_barrier
    s_cmp_eq_u32 s3, 1
    s_cbranch_scc1 XV1__20
    s_cmp_eq_u32 s3, 2
    s_cbranch_scc1 XV2__21
    s_cmp_eq_u32 s3, 3
    s_cbranch_scc1 XV3__22
XV0__19:
    ds_write_b128 v3, v[80:83] offset:4096
    ds_write_b128 v3, v[84:87] offset:5120
    ds_write_b128 v3, v[88:91] offset:6144
    ds_write_b128 v3, v[92:95] offset:7168
    ds_write_b128 v3, v[96:99] offset:8192
    ds_write_b128 v3, v[100:103] offset:9216
    ds_write_b128 v3, v[104:107] offset:10240
    ds_write_b128 v3, v[108:111] offset:11264
    s_waitcnt lgkmcnt(4)
    ds_write_b128 v3, v[112:115] offset:12288
    ds_write_b128 v3, v[116:119] offset:13312
    ds_write_b128 v3, v[120:123] offset:14336
    ds_write_b128 v3, v[124:127] offset:15360
    ds_read_b128 v[192:195], v5 offset:0
    ds_read_b128 v[196:199], v5 offset:1024
    ds_read_b128 v[200:203], v5 offset:2048
    ds_read_b128 v[204:207], v5 offset:3072
    s_waitcnt lgkmcnt(8)
    ds_read_b128 v[208:211], v5 offset:4096
    ds_read_b128 v[212:215], v5 offset:5120
    ds_read_b128 v[216:219], v5 offset:6144
    ds_read_b128 v[220:223], v5 offset:7168
    s_waitcnt lgkmcnt(8)
    ds_read_b128 v[224:227], v5 offset:8192
    ds_read_b128 v[228:231], v5 offset:9216
    ds_read_b128 v[232:235], v5 offset:10240
    ds_read_b128 v[236:239], v5 offset:11264
    s_waitcnt lgkmcnt(8)
    ds_read_b128 v[240:243], v5 offset:12288
    ds_read_b128 v[244:247], v5 offset:13312
    ds_read_b128 v[248:251], v5 offset:14336
    ds_read_b128 v[252:255], v5 offset:15360
    v_pk_mul_f32 v[128:129], v[64:65], 1.0 op_sel_hi:[1,0]
    v_pk_mul_f32 v[130:131], v[66:67], 1.0 op_sel_hi:[1,0]
    v_pk_mul_f32 v[132:133], v[68:69], 1.0 op_sel_hi:[1,0]
    v_pk_mul_f32 v[134:135], v[70:71], 1.0 op_sel_hi:[1,0]
    v_pk_mul_f32 v[136:137], v[72:73], 1.0 op_sel_hi:[1,0]
    v_pk_mul_f32 v[138:139], v[74:75], 1.0 op_sel_hi:[1,0]
    v_pk_mul_f32 v[140:141], v[76:77], 1.0 op_sel_hi:[1,0]
    v_pk_mul_f32 v[142:143], v[78:79], 1.0 op_sel_hi:[1,0]
    s_waitcnt lgkmcnt(0)
    s_barrier
    ds_read_b128 v[144:147], v6 offset:49152
    ds_read_b128 v[148:151], v6 offset:50176
    ds_read_b128 v[152:155], v6 offset:51200
    ds_read_b128 v[156:159], v6 offset:52224
    ds_read_b128 v[160:163], v7 offset:0
    ds_read_b128 v[164:167], v7 offset:1024
    ds_read_b128 v[168:171], v7 offset:2048
    ds_read_b128 v[172:175], v7 offset:3072
    ds_read_b128 v[176:179], v7 offset:16384
    ds_read_b128 v[180:183], v7 offset:17408
    ds_read_b128 v[184:187], v7 offset:18432
    ds_read_b128 v[188:191], v7 offset:19456
    s_branch XDONE_18
XV1__20:
    ds_write_b128 v3, v[64:67] offset:0
    ds_write_b128 v3, v[68:71] offset:1024
    ds_write_b128 v3, v[72:75] offset:2048
    ds_write_b128 v3, v[76:79] offset:3072
    ds_write_b128 v3, v[96:99] offset:8192
    ds_write_b128 v3, v[100:103] offset:9216
    ds_write_b128 v3, v[104:107] offset:10240
    ds_write_b128 v3, v[108:111] offset:11264
    s_waitcnt lgkmcnt(4)
    ds_write_b128 v3, v[112:115] offset:12288
    ds_write_b128 v3, v[116:119] offset:13312
    ds_write_b128 v3, v[120:123] offset:14336
    ds_write_b128 v3, v[124:127] offset:15360
    ds_read_b128 v[192:195], v5 offset:0
    ds_read_b128 v[196:199], v5 offset:1024
    ds_read_b128 v[200:203], v5 offset:2048
    ds_read_b128 v[204:207], v5 offset:3072
    s_waitcnt lgkmcnt(8)
    ds_read_b128 v[208:211], v5 offset:4096
    ds_read_b128 v[212:215], v5 offset:5120
    ds_read_b128 v[216:219], v5 offset:6144
    ds_read_b128 v[220:223], v5 offset:7168
    s_waitcnt lgkmcnt(8)
    ds_read_b128 v[224:227], v5 offset:8192
    ds_read_b128 v[228:231], v5 offset:9216
    ds_read_b128 v[232:235], v5 offset:10240
    ds_read_b128 v[236:239], v5 offset:11264
    s_waitcnt lgkmcnt(8)
    ds_read_b128 v[240:243], v5 offset:12288
    ds_read_b128 v[244:247], v5 offset:13312
    ds_read_b128 v[248:251], v5 offset:14336
    ds_read_b128 v[252:255], v5 offset:15360
    v_pk_mul_f32 v[128:129], v[80:81], 1.0 op_sel_hi:[1,0]
    v_pk_mul_f32 v[130:131], v[82:83], 1.0 op_sel_hi:[1,0]
    v_pk_mul_f32 v[132:133], v[84:85], 1.0 op_sel_hi:[1,0]
    v_pk_mul_f32 v[134:135], v[86:87], 1.0 op_sel_hi:[1,0]
    v_pk_mul_f32 v[136:137], v[88:89], 1.0 op_sel_hi:[1,0]
    v_pk_mul_f32 v[138:139], v[90:91], 1.0 op_sel_hi:[1,0]
    v_pk_mul_f32 v[140:141], v[92:93], 1.0 op_sel_hi:[1,0]
    v_pk_mul_f32 v[142:143], v[94:95], 1.0 op_sel_hi:[1,0]
    s_waitcnt lgkmcnt(0)
    s_barrier
    ds_read_b128 v[144:147], v6 offset:0
    ds_read_b128 v[148:151], v6 offset:1024
    ds_read_b128 v[152:155], v6 offset:2048
    ds_read_b128 v[156:159], v6 offset:3072
    ds_read_b128 v[160:163], v7 offset:0
    ds_read_b128 v[164:167], v7 offset:1024
    ds_read_b128 v[168:171], v7 offset:2048
    ds_read_b128 v[172:175], v7 offset:3072
    ds_read_b128 v[176:179], v7 offset:16384
    ds_read_b128 v[180:183], v7 offset:17408
    ds_read_b128 v[184:187], v7 offset:18432
    ds_read_b128 v[188:191], v7 offset:19456
    s_branch XDONE_18
XV2__21:
    ds_write_b128 v3, v[64:67] offset:0
    ds_write_b128 v3, v[68:71] offset:1024
    ds_write_b128 v3, v[72:75] offset:2048
    ds_write_b128 v3, v[76:79] offset:3072
    ds_write_b128 v3, v[80:83] offset:4096
    ds_write_b128 v3, v[84:87] offset:5120
    ds_write_b128 v3, v[88:91] offset:6144
    ds_write_b128 v3, v[92:95] offset:7168
    s_waitcnt lgkmcnt(4)
    ds_write_b128 v3, v[112:115] offset:12288
    ds_write_b128 v3, v[116:119] offset:13312
    ds_write_b128 v3, v[120:123] offset:14336
    ds_write_b128 v3, v[124:127] offset:15360
    ds_read_b128 v[192:195], v5 offset:0
    ds_read_b128 v[196:199], v5 offset:1024
    ds_read_b128 v[200:203], v5 offset:2048
    ds_read_b128 v[204:207], v5 offset:3072
    s_waitcnt lgkmcnt(8)
    ds_read_b128 v[208:211], v5 offset:4096
    ds_read_b128 v[212:215], v5 offset:5120
    ds_read_b128 v[216:219], v5 offset:6144
    ds_read_b128 v[220:223], v5 offset:7168
    s_waitcnt lgkmcnt(8)
    ds_read_b128 v[224:227], v5 offset:8192
    ds_read_b128 v[228:231], v5 offset:9216
    ds_read_b128 v[232:235], v5 offset:10240
    ds_read_b128 v[236:239], v5 offset:11264
    s_waitcnt lgkmcnt(8)
    ds_read_b128 v[240:243], v5 offset:12288
    ds_read_b128 v[244:247], v5 offset:13312
    ds_read_b128 v[248:251], v5 offset:14336
    ds_read_b128 v[252:255], v5 offset:15360
    v_pk_mul_f32 v[128:129], v[96:97], 1.0 op_sel_hi:[1,0]
    v_pk_mul_f32 v[130:131], v[98:99], 1.0 op_sel_hi:[1,0]
    v_pk_mul_f32 v[132:133], v[100:101], 1.0 op_sel_hi:[1,0]
    v_pk_mul_f32 v[134:135], v[102:103], 1.0 op_sel_hi:[1,0]
    v_pk_mul_f32 v[136:137], v[104:105], 1.0 op_sel_hi:[1,0]
    v_pk_mul_f32 v[138:139], v[106:107], 1.0 op_sel_hi:[1,0]
    v_pk_mul_f32 v[140:141], v[108:109], 1.0 op_sel_hi:[1,0]
    v_pk_mul_f32 v[142:143], v[110:111], 1.0 op_sel_hi:[1,0]
    s_waitcnt lgkmcnt(0)
    s_barrier
    ds_read_b128 v[144:147], v6 offset:0
    ds_read_b128 v[148:151], v6 offset:1024
    ds_read_b128 v[152:155], v6 offset:2048
    ds_read_b128 v[156:159], v6 offset:3072
    ds_read_b128 v[160:163], v6 offset:49152
    ds_read_b128 v[164:167], v6 offset:50176
    ds_read_b128 v[168:171], v6 offset:51200
    ds_read_b128 v[172:175], v6 offset:52224
    ds_read_b128 v[176:179], v7 offset:16384
    ds_read_b128 v[180:183], v7 offset:17408
    ds_read_b128 v[184:187], v7 offset:18432
    ds_read_b128 v[188:191], v7 offset:19456
    s_branch XDONE_18
XV3__22:
    ds_write_b128 v3, v[64:67] offset:0
    ds_write_b128 v3, v[68:71] offset:1024
    ds_write_b128 v3, v[72:75] offset:2048
    ds_write_b128 v3, v[76:79] offset:3072
    ds_write_b128 v3, v[80:83] offset:4096
    ds_write_b128 v3, v[84:87] offset:5120
    ds_write_b128 v3, v[88:91] offset:6144
    ds_write_b128 v3, v[92:95] offset:7168
    s_waitcnt lgkmcnt(4)
    ds_write_b128 v3, v[96:99] offset:8192
    ds_write_b128 v3, v[100:103] offset:9216
    ds_write_b128 v3, v[104:107] offset:10240
    ds_write_b128 v3, v[108:111] offset:11264
    ds_read_b128 v[192:195], v5 offset:0
    ds_read_b128 v[196:199], v5 offset:1024
    ds_read_b128 v[200:203], v5 offset:2048
    ds_read_b128 v[204:207], v5 offset:3072
    s_waitcnt lgkmcnt(8)
    ds_read_b128 v[208:211], v5 offset:4096
    ds_read_b128 v[212:215], v5 offset:5120
    ds_read_b128 v[216:219], v5 offset:6144
    ds_read_b128 v[220:223], v5 offset:7168
    s_waitcnt lgkmcnt(8)
    ds_read_b128 v[224:227], v5 offset:8192
    ds_read_b128 v[228:231], v5 offset:9216
    ds_read_b128 v[232:235], v5 offset:10240
    ds_read_b128 v[236:239], v5 offset:11264
    s_waitcnt lgkmcnt(8)
    ds_read_b128 v[240:243], v5 offset:12288
    ds_read_b128 v[244:247], v5 offset:13312
    ds_read_b128 v[248:251], v5 offset:14336
    ds_read_b128 v[252:255], v5 offset:15360
    v_pk_mul_f32 v[128:129], v[112:113], 1.0 op_sel_hi:[1,0]
    v_pk_mul_f32 v[130:131], v[114:115], 1.0 op_sel_hi:[1,0]
    v_pk_mul_f32 v[132:133], v[116:117], 1.0 op_sel_hi:[1,0]
    v_pk_mul_f32 v[134:135], v[118:119], 1.0 op_sel_hi:[1,0]
    v_pk_mul_f32 v[136:137], v[120:121], 1.0 op_sel_hi:[1,0]
    v_pk_mul_f32 v[138:139], v[122:123], 1.0 op_sel_hi:[1,0]
    v_pk_mul_f32 v[140:141], v[124:125], 1.0 op_sel_hi:[1,0]
    v_pk_mul_f32 v[142:143], v[126:127], 1.0 op_sel_hi:[1,0]
    s_waitcnt lgkmcnt(0)
    s_barrier
    ds_read_b128 v[144:147], v6 offset:0
    ds_read_b128 v[148:151], v6 offset:1024
    ds_read_b128 v[152:155], v6 offset:2048
    ds_read_b128 v[156:159], v6 offset:3072
    ds_read_b128 v[160:163], v6 offset:49152
    ds_read_b128 v[164:167], v6 offset:50176
    ds_read_b128 v[168:171], v6 offset:51200
    ds_read_b128 v[172:175], v6 offset:52224
    ds_read_b128 v[176:179], v7 offset:0
    ds_read_b128 v[180:183], v7 offset:1024
    ds_read_b128 v[184:187], v7 offset:2048
    ds_read_b128 v[188:191], v7 offset:3072
XDONE_18:
    v_pk_add_f32 v[192:193], v[192:193], v[208:209]
    v_pk_add_f32 v[224:225], v[224:225], v[240:241]
    v_pk_add_f32 v[194:195], v[194:195], v[210:211]
    v_pk_add_f32 v[226:227], v[226:227], v[242:243]
    v_pk_add_f32 v[196:197], v[196:197], v[212:213]
    v_pk_add_f32 v[228:229], v[228:229], v[244:245]
    v_pk_add_f32 v[198:199], v[198:199], v[214:215]
    v_pk_add_f32 v[230:231], v[230:231], v[246:247]
    v_pk_add_f32 v[200:201], v[200:201], v[216:217]
    v_pk_add_f32 v[232:233], v[232:233], v[248:249]
    v_pk_add_f32 v[202:203], v[202:203], v[218:219]
    v_pk_add_f32 v[234:235], v[234:235], v[250:251]
    v_pk_add_f32 v[204:205], v[204:205], v[220:221]
    v_pk_add_f32 v[236:237], v[236:237], v[252:253]
    v_pk_add_f32 v[206:207], v[206:207], v[222:223]
    v_pk_add_f32 v[238:239], v[238:239], v[254:255]
    v_pk_add_f32 v[192:193], v[192:193], v[224:225]
    v_pk_add_f32 v[194:195], v[194:195], v[226:227]
    v_pk_add_f32 v[196:197], v[196:197], v[228:229]
    v_pk_add_f32 v[198:199], v[198:199], v[230:231]
    v_pk_add_f32 v[200:201], v[200:201], v[232:233]
    v_pk_add_f32 v[202:203], v[202:203], v[234:235]
    v_pk_add_f32 v[204:205], v[204:205], v[236:237]
    v_pk_add_f32 v[206:207], v[206:207], v[238:239]
    v_pk_fma_f32 v[128:129], v[192:193], v[40:41], v[128:129]
    v_pk_fma_f32 v[130:131], v[194:195], v[40:41], v[130:131]
    v_pk_fma_f32 v[132:133], v[196:197], v[40:41], v[132:133]
    v_pk_fma_f32 v[134:135], v[198:199], v[40:41], v[134:135]
    v_pk_fma_f32 v[136:137], v[200:201], v[40:41], v[136:137]
    v_pk_fma_f32 v[138:139], v[202:203], v[40:41], v[138:139]
    v_pk_fma_f32 v[140:141], v[204:205], v[40:41], v[140:141]
    v_pk_fma_f32 v[142:143], v[206:207], v[40:41], v[142:143]
    s_waitcnt lgkmcnt(0)
    v_pk_add_f32 v[144:145], v[144:145], v[160:161]
    v_pk_add_f32 v[128:129], v[128:129], v[176:177]
    v_pk_add_f32 v[146:147], v[146:147], v[162:163]
    v_pk_add_f32 v[130:131], v[130:131], v[178:179]
    v_pk_add_f32 v[148:149], v[148:149], v[164:165]
    v_pk_add_f32 v[132:133], v[132:133], v[180:181]
    v_pk_add_f32 v[150:151], v[150:151], v[166:167]
    v_pk_add_f32 v[134:135], v[134:135], v[182:183]
    v_pk_add_f32 v[152:153], v[152:153], v[168:169]
    v_pk_add_f32 v[136:137], v[136:137], v[184:185]
    v_pk_add_f32 v[154:155], v[154:155], v[170:171]
    v_pk_add_f32 v[138:139], v[138:139], v[186:187]
    v_pk_add_f32 v[156:157], v[156:157], v[172:173]
    v_pk_add_f32 v[140:141], v[140:141], v[188:189]
    v_pk_add_f32 v[158:159], v[158:159], v[174:175]
    v_pk_add_f32 v[142:143], v[142:143], v[190:191]
    v_pk_add_f32 v[128:129], v[128:129], v[144:145]
    v_pk_add_f32 v[130:131], v[130:131], v[146:147]
    v_pk_add_f32 v[132:133], v[132:133], v[148:149]
    v_pk_add_f32 v[134:135], v[134:135], v[150:151]
    v_pk_add_f32 v[136:137], v[136:137], v[152:153]
    v_pk_add_f32 v[138:139], v[138:139], v[154:155]
    v_pk_add_f32 v[140:141], v[140:141], v[156:157]
    v_pk_add_f32 v[142:143], v[142:143], v[158:159]
    v_cvt_pk_bf16_f32 v96, v128, v129
    v_cvt_pk_bf16_f32 v97, v130, v131
    v_cvt_pk_bf16_f32 v98, v132, v133
    v_cvt_pk_bf16_f32 v99, v134, v135
    v_cvt_pk_bf16_f32 v100, v136, v137
    v_cvt_pk_bf16_f32 v101, v138, v139
    v_cvt_pk_bf16_f32 v102, v140, v141
    v_cvt_pk_bf16_f32 v103, v142, v143
    s_nop 1
    v_permlane32_swap_b32 v96, v98
    v_permlane32_swap_b32 v97, v99
    v_permlane32_swap_b32 v100, v102
    v_permlane32_swap_b32 v101, v103
    buffer_store_dwordx4 v[96:99], v8, s[28:31], 0 offen offset:0 nt
    buffer_store_dwordx4 v[100:103], v8, s[28:31], 0 offen offset:32 nt
    s_endpgm
P1_DFT:
    s_sub_u32 s42, s42, 28
    s_and_b32 s63, s41, 1
    s_lshr_b32 s77, s41, 1
    s_lshl_b32 s77, s77, 2
    s_add_u32 s62, s77, s42
    s_cmp_ge_u32 s40, 4
    s_cbranch_scc1 P1_D_LOADER
    v_and_b32 v26, 31, v1
    v_lshrrev_b32 v27, 5, v1
    v_lshrrev_b32 v28, 1, v26
    v_and_b32 v28, 7, v28
    v_lshlrev_b32 v29, 7, v26
    s_lshl_b32 s41, s64, 5
    v_add_u32 v31, s41, v26
    v_lshlrev_b32 v31, 7, v31
    v_add_u32 v31, 0x10000, v31
    v_add_u32 v30, 0, v27
    v_xor_b32 v30, v30, v28
    v_lshlrev_b32 v30, 4, v30
    v_add_u32 v10, v29, v30
    v_add_u32 v14, v31, v30
    v_add_u32 v18, 0x10000, v14
    v_add_u32 v30, 2, v27
    v_xor_b32 v30, v30, v28
    v_lshlrev_b32 v30, 4, v30
    v_add_u32 v11, v29, v30
    v_add_u32 v15, v31, v30
    v_add_u32 v19, 0x10000, v15
    v_add_u32 v30, 4, v27
    v_xor_b32 v30, v30, v28
    v_lshlrev_b32 v30, 4, v30
    v_add_u32 v12, v29, v30
    v_add_u32 v16, v31, v30
    v_add_u32 v20, 0x10000, v16
    v_add_u32 v30, 6, v27
    v_xor_b32 v30, v30, v28
    v_lshlrev_b32 v30, 4, v30
    v_add_u32 v13, v29, v30
    v_add_u32 v17, v31, v30
    v_add_u32 v21, 0x10000, v17
    s_waitcnt lgkmcnt(0)
    s_mov_b32 s20, s74
    s_and_b32 s21, s75, 0xffff
    s_mov_b32 s22, 0x1000000
    s_mov_b32 s23, 0x20000
    s_lshl_b32 s41, s62, 1
    s_add_u32 s41, s41, s63
    s_lshl_b32 s42, s41, 2
    s_movk_i32 s41, 8192
    s_add_u32 s41, s41, s42
    s_add_u32 s99, s41, 0x910000
    s_mov_b32 s36, s72
    s_and_b32 s37, s73, 0xffff
    s_mov_b32 s38, 0x100
    s_mov_b32 s39, 0x20000
    s_or_b32 s41, s2, s40
    s_cmp_lg_u32 s41, 0
    s_cbranch_scc1 NONCE_23
    s_memrealtime s[42:43]
    s_waitcnt lgkmcnt(0)
    s_or_b32 s42, s42, 1
    v_mov_b32 v4, s42
    v_lshlrev_b32 v5, 20, v1
    buffer_store_dword v4, v5, s[36:39], 0 offen sc1
NONCE_23:
    v_mov_b32 v7, 0
    s_mov_b32 s8, s44
    s_and_b32 s9, s45, 0xffff
    s_mov_b32 s10, 0x1c0000
    s_mov_b32 s11, 0x20000
    s_mov_b32 s24, s58
    s_and_b32 s25, s59, 0xffff
    s_mov_b32 s26, 0x380
    s_mov_b32 s27, 0x20000
    s_mov_b32 s65, s40
    s_lshl_b32 s41, s62, 1
    s_add_u32 s41, s41, s63
    s_lshl_b32 s5, s41, 6
    s_lshl_b32 s42, s65, 4
    s_add_u32 s5, s5, s42
    v_and_b32 v104, 15, v1
    v_lshrrev_b32 v105, 4, v1
    v_lshlrev_b32 v106, 4, v104
    v_cmp_gt_u32 vcc, 14, v104
    v_mov_b32 v107, 0x7fffffff
    s_nop 0
    v_cndmask_b32 v106, v107, v106, vcc
    buffer_load_dwordx4 v[184:187], v106, s[24:27], 0 offen offset:0
    buffer_load_dwordx4 v[188:191], v106, s[24:27], 0 offen offset:224
    buffer_load_dwordx4 v[192:195], v106, s[24:27], 0 offen offset:448
    buffer_load_dwordx4 v[196:199], v106, s[24:27], 0 offen offset:672
    s_lshl_b32 s42, s65, 9
    s_add_u32 s42, s42, s41
    s_mul_i32 s42, s42, 896
    v_mul_u32_u24 v108, 28672, v105
    v_add_u32 v108, s42, v108
    v_add_u32 v108, v108, v106
    v_cndmask_b32 v108, v107, v108, vcc
    s_mov_b32 s68, 0
    buffer_load_dwordx4 v[120:123], v108, s[8:11], s68 offen offset:0
    buffer_load_dwordx4 v[124:127], v108, s[8:11], s68 offen offset:224
    buffer_load_dwordx4 v[128:131], v108, s[8:11], s68 offen offset:448
    buffer_load_dwordx4 v[132:135], v108, s[8:11], s68 offen offset:672
    s_mov_b32 s68, 114688
    buffer_load_dwordx4 v[136:139], v108, s[8:11], s68 offen offset:0
    buffer_load_dwordx4 v[140:143], v108, s[8:11], s68 offen offset:224
    buffer_load_dwordx4 v[144:147], v108, s[8:11], s68 offen offset:448
    buffer_load_dwordx4 v[148:151], v108, s[8:11], s68 offen offset:672
    s_mov_b32 s68, 229376
    buffer_load_dwordx4 v[152:155], v108, s[8:11], s68 offen offset:0
    buffer_load_dwordx4 v[156:159], v108, s[8:11], s68 offen offset:224
    buffer_load_dwordx4 v[160:163], v108, s[8:11], s68 offen offset:448
    buffer_load_dwordx4 v[164:167], v108, s[8:11], s68 offen offset:672
    s_mov_b32 s68, 344064
    buffer_load_dwordx4 v[168:171], v108, s[8:11], s68 offen offset:0
    buffer_load_dwordx4 v[172:175], v108, s[8:11], s68 offen offset:224
    buffer_load_dwordx4 v[176:179], v108, s[8:11], s68 offen offset:448
    buffer_load_dwordx4 v[180:183], v108, s[8:11], s68 offen offset:672
    s_waitcnt vmcnt(0)
    v_mov_b32 v109, 0
    v_dot2_f32_bf16 v109, v120, v184, v109
    v_dot2_f32_bf16 v109, v121, v185, v109
    v_dot2_f32_bf16 v109, v122, v186, v109
    v_dot2_f32_bf16 v109, v123, v187, v109
    v_dot2_f32_bf16 v109, v124, v188, v109
    v_dot2_f32_bf16 v109, v125, v189, v109
    v_dot2_f32_bf16 v109, v126, v190, v109
    v_dot2_f32_bf16 v109, v127, v191, v109
    v_dot2_f32_bf16 v109, v128, v192, v109
    v_dot2_f32_bf16 v109, v129, v193, v109
    v_dot2_f32_bf16 v109, v130, v194, v109
    v_dot2_f32_bf16 v109, v131, v195, v109
    v_dot2_f32_bf16 v109, v132, v196, v109
    v_dot2_f32_bf16 v109, v133, v197, v109
    v_dot2_f32_bf16 v109, v134, v198, v109
    v_dot2_f32_bf16 v109, v135, v199, v109
    s_nop 2
    v_add_f32_dpp v109, v109, v109 row_shr:1 row_mask:0xf bank_mask:0xf bound_ctrl:0
    s_nop 1
    v_add_f32_dpp v109, v109, v109 row_shr:2 row_mask:0xf bank_mask:0xf bound_ctrl:0
    s_nop 1
    v_add_f32_dpp v109, v109, v109 row_shr:4 row_mask:0xf bank_mask:0xf bound_ctrl:0
    s_nop 1
    v_add_f32_dpp v109, v109, v109 row_shr:8 row_mask:0xf bank_mask:0xf bound_ctrl:0
    s_nop 1
    v_mul_f32 v109, 0xbfb8aa3b, v109
    v_exp_f32 v109, v109
    s_nop 0
    v_add_f32 v109, 1.0, v109
    v_rcp_f32 v109, v109
    v_add_u32 v110, s5, v105
    v_add_u32 v110, 0, v110
    v_lshlrev_b32 v110, 2, v110
    v_add_u32 v110, 0x900000, v110
    v_cmp_eq_u32 vcc, 15, v104
    s_nop 1
    v_cndmask_b32 v110, v107, v110, vcc
    buffer_store_dword v109, v110, s[20:23], 0 offen sc1
    v_mov_b32 v109, 0
    v_dot2_f32_bf16 v109, v136, v184, v109
    v_dot2_f32_bf16 v109, v137, v185, v109
    v_dot2_f32_bf16 v109, v138, v186, v109
    v_dot2_f32_bf16 v109, v139, v187, v109
    v_dot2_f32_bf16 v109, v140, v188, v109
    v_dot2_f32_bf16 v109, v141, v189, v109
    v_dot2_f32_bf16 v109, v142, v190, v109
    v_dot2_f32_bf16 v109, v143, v191, v109
    v_dot2_f32_bf16 v109, v144, v192, v109
    v_dot2_f32_bf16 v109, v145, v193, v109
    v_dot2_f32_bf16 v109, v146, v194, v109
    v_dot2_f32_bf16 v109, v147, v195, v109
    v_dot2_f32_bf16 v109, v148, v196, v109
    v_dot2_f32_bf16 v109, v149, v197, v109
    v_dot2_f32_bf16 v109, v150, v198, v109
    v_dot2_f32_bf16 v109, v151, v199, v109
    s_nop 2
    v_add_f32_dpp v109, v109, v109 row_shr:1 row_mask:0xf bank_mask:0xf bound_ctrl:0
    s_nop 1
    v_add_f32_dpp v109, v109, v109 row_shr:2 row_mask:0xf bank_mask:0xf bound_ctrl:0
    s_nop 1
    v_add_f32_dpp v109, v109, v109 row_shr:4 row_mask:0xf bank_mask:0xf bound_ctrl:0
    s_nop 1
    v_add_f32_dpp v109, v109, v109 row_shr:8 row_mask:0xf bank_mask:0xf bound_ctrl:0
    s_nop 1
    v_mul_f32 v109, 0xbfb8aa3b, v109
    v_exp_f32 v109, v109
    s_nop 0
    v_add_f32 v109, 1.0, v109
    v_rcp_f32 v109, v109
    v_add_u32 v110, s5, v105
    v_add_u32 v110, 4, v110
    v_lshlrev_b32 v110, 2, v110
    v_add_u32 v110, 0x900000, v110
    v_cmp_eq_u32 vcc, 15, v104
    s_nop 1
    v_cndmask_b32 v110, v107, v110, vcc
    buffer_store_dword v109, v110, s[20:23], 0 offen sc1
    v_mov_b32 v109, 0
    v_dot2_f32_bf16 v109, v152, v184, v109
    v_dot2_f32_bf16 v109, v153, v185, v109
    v_dot2_f32_bf16 v109, v154, v186, v109
    v_dot2_f32_bf16 v109, v155, v187, v109
    v_dot2_f32_bf16 v109, v156, v188, v109
    v_dot2_f32_bf16 v109, v157, v189, v109
    v_dot2_f32_bf16 v109, v158, v190, v109
    v_dot2_f32_bf16 v109, v159, v191, v109
    v_dot2_f32_bf16 v109, v160, v192, v109
    v_dot2_f32_bf16 v109, v161, v193, v109
    v_dot2_f32_bf16 v109, v162, v194, v109
    v_dot2_f32_bf16 v109, v163, v195, v109
    v_dot2_f32_bf16 v109, v164, v196, v109
    v_dot2_f32_bf16 v109, v165, v197, v109
    v_dot2_f32_bf16 v109, v166, v198, v109
    v_dot2_f32_bf16 v109, v167, v199, v109
    s_nop 2
    v_add_f32_dpp v109, v109, v109 row_shr:1 row_mask:0xf bank_mask:0xf bound_ctrl:0
    s_nop 1
    v_add_f32_dpp v109, v109, v109 row_shr:2 row_mask:0xf bank_mask:0xf bound_ctrl:0
    s_nop 1
    v_add_f32_dpp v109, v109, v109 row_shr:4 row_mask:0xf bank_mask:0xf bound_ctrl:0
    s_nop 1
    v_add_f32_dpp v109, v109, v109 row_shr:8 row_mask:0xf bank_mask:0xf bound_ctrl:0
    s_nop 1
    v_mul_f32 v109, 0xbfb8aa3b, v109
    v_exp_f32 v109, v109
    s_nop 0
    v_add_f32 v109, 1.0, v109
    v_rcp_f32 v109, v109
    v_add_u32 v110, s5, v105
    v_add_u32 v110, 8, v110
    v_lshlrev_b32 v110, 2, v110
    v_add_u32 v110, 0x900000, v110
    v_cmp_eq_u32 vcc, 15, v104
    s_nop 1
    v_cndmask_b32 v110, v107, v110, vcc
    buffer_store_dword v109, v110, s[20:23], 0 offen sc1
    v_mov_b32 v109, 0
    v_dot2_f32_bf16 v109, v168, v184, v109
    v_dot2_f32_bf16 v109, v169, v185, v109
    v_dot2_f32_bf16 v109, v170, v186, v109
    v_dot2_f32_bf16 v109, v171, v187, v109
    v_dot2_f32_bf16 v109, v172, v188, v109
    v_dot2_f32_bf16 v109, v173, v189, v109
    v_dot2_f32_bf16 v109, v174, v190, v109
    v_dot2_f32_bf16 v109, v175, v191, v109
    v_dot2_f32_bf16 v109, v176, v192, v109
    v_dot2_f32_bf16 v109, v177, v193, v109
    v_dot2_f32_bf16 v109, v178, v194, v109
    v_dot2_f32_bf16 v109, v179, v195, v109
    v_dot2_f32_bf16 v109, v180, v196, v109
    v_dot2_f32_bf16 v109, v181, v197, v109
    v_dot2_f32_bf16 v109, v182, v198, v109
    v_dot2_f32_bf16 v109, v183, v199, v109
    s_nop 2
    v_add_f32_dpp v109, v109, v109 row_shr:1 row_mask:0xf bank_mask:0xf bound_ctrl:0
    s_nop 1
    v_add_f32_dpp v109, v109, v109 row_shr:2 row_mask:0xf bank_mask:0xf bound_ctrl:0
    s_nop 1
    v_add_f32_dpp v109, v109, v109 row_shr:4 row_mask:0xf bank_mask:0xf bound_ctrl:0
    s_nop 1
    v_add_f32_dpp v109, v109, v109 row_shr:8 row_mask:0xf bank_mask:0xf bound_ctrl:0
    s_nop 1
    v_mul_f32 v109, 0xbfb8aa3b, v109
    v_exp_f32 v109, v109
    s_nop 0
    v_add_f32 v109, 1.0, v109
    v_rcp_f32 v109, v109
    v_add_u32 v110, s5, v105
    v_add_u32 v110, 12, v110
    v_lshlrev_b32 v110, 2, v110
    v_add_u32 v110, 0x900000, v110
    v_cmp_eq_u32 vcc, 15, v104
    s_nop 1
    v_cndmask_b32 v110, v107, v110, vcc
    buffer_store_dword v109, v110, s[20:23], 0 offen sc1
    s_barrier
    ds_read_b128 v[208:211], v14 offset:0
    ds_read_b128 v[192:195], v10 offset:0
    ds_read_b128 v[212:215], v14 offset:16384
    ds_read_b128 v[196:199], v10 offset:4096
    ds_read_b128 v[200:203], v10 offset:8192
    ds_read_b128 v[204:207], v10 offset:12288
    s_waitcnt lgkmcnt(4)
    v_mfma_f32_32x32x16_bf16 v[64:79], v[192:195], v[208:211], 0
    ds_read_b128 v[232:235], v15 offset:0
    s_waitcnt lgkmcnt(4)
    v_mfma_f32_32x32x16_bf16 v[128:143], v[192:195], v[212:215], 0
    ds_read_b128 v[216:219], v11 offset:0
    s_waitcnt lgkmcnt(4)
    v_mfma_f32_32x32x16_bf16 v[80:95], v[196:199], v[208:211], 0
    ds_read_b128 v[236:239], v15 offset:16384
    v_mfma_f32_32x32x16_bf16 v[144:159], v[196:199], v[212:215], 0
    ds_read_b128 v[220:223], v11 offset:4096
    s_waitcnt lgkmcnt(5)
    v_mfma_f32_32x32x16_bf16 v[96:111], v[200:203], v[208:211], 0
    ds_read_b128 v[224:227], v11 offset:8192
    v_mfma_f32_32x32x16_bf16 v[160:175], v[200:203], v[212:215], 0
    ds_read_b128 v[228:231], v11 offset:12288
    s_waitcnt lgkmcnt(6)
    v_mfma_f32_32x32x16_bf16 v[112:127], v[204:207], v[208:211], 0
    v_mfma_f32_32x32x16_bf16 v[176:191], v[204:207], v[212:215], 0
    s_waitcnt lgkmcnt(4)
    v_mfma_f32_32x32x16_bf16 v[64:79], v[216:219], v[232:235], v[64:79]
    ds_read_b128 v[208:211], v16 offset:0
    s_waitcnt lgkmcnt(4)
    v_mfma_f32_32x32x16_bf16 v[128:143], v[216:219], v[236:239], v[128:143]
    ds_read_b128 v[192:195], v12 offset:0
    s_waitcnt lgkmcnt(4)
    v_mfma_f32_32x32x16_bf16 v[80:95], v[220:223], v[232:235], v[80:95]
    ds_read_b128 v[212:215], v16 offset:16384
    v_mfma_f32_32x32x16_bf16 v[144:159], v[220:223], v[236:239], v[144:159]
    ds_read_b128 v[196:199], v12 offset:4096
    s_waitcnt lgkmcnt(5)
    v_mfma_f32_32x32x16_bf16 v[96:111], v[224:227], v[232:235], v[96:111]
    ds_read_b128 v[200:203], v12 offset:8192
    v_mfma_f32_32x32x16_bf16 v[160:175], v[224:227], v[236:239], v[160:175]
    ds_read_b128 v[204:207], v12 offset:12288
    s_waitcnt lgkmcnt(6)
    v_mfma_f32_32x32x16_bf16 v[112:127], v[228:231], v[232:235], v[112:127]
    v_mfma_f32_32x32x16_bf16 v[176:191], v[228:231], v[236:239], v[176:191]
    s_barrier
    s_waitcnt lgkmcnt(4)
    v_mfma_f32_32x32x16_bf16 v[64:79], v[192:195], v[208:211], v[64:79]
    ds_read_b128 v[232:235], v17 offset:0
    s_waitcnt lgkmcnt(4)
    v_mfma_f32_32x32x16_bf16 v[128:143], v[192:195], v[212:215], v[128:143]
    ds_read_b128 v[216:219], v13 offset:0
    s_waitcnt lgkmcnt(4)
    v_mfma_f32_32x32x16_bf16 v[80:95], v[196:199], v[208:211], v[80:95]
    ds_read_b128 v[236:239], v17 offset:16384
    v_mfma_f32_32x32x16_bf16 v[144:159], v[196:199], v[212:215], v[144:159]
    ds_read_b128 v[220:223], v13 offset:4096
    s_waitcnt lgkmcnt(5)
    v_mfma_f32_32x32x16_bf16 v[96:111], v[200:203], v[208:211], v[96:111]
    ds_read_b128 v[224:227], v13 offset:8192
    v_mfma_f32_32x32x16_bf16 v[160:175], v[200:203], v[212:215], v[160:175]
    ds_read_b128 v[228:231], v13 offset:12288
    s_waitcnt lgkmcnt(6)
    v_mfma_f32_32x32x16_bf16 v[112:127], v[204:207], v[208:211], v[112:127]
    v_mfma_f32_32x32x16_bf16 v[176:191], v[204:207], v[212:215], v[176:191]
    s_waitcnt lgkmcnt(4)
    v_mfma_f32_32x32x16_bf16 v[64:79], v[216:219], v[232:235], v[64:79]
    ds_read_b128 v[208:211], v14 offset:32768
    s_waitcnt lgkmcnt(4)
    v_mfma_f32_32x32x16_bf16 v[128:143], v[216:219], v[236:239], v[128:143]
    ds_read_b128 v[192:195], v10 offset:16384
    s_waitcnt lgkmcnt(4)
    v_mfma_f32_32x32x16_bf16 v[80:95], v[220:223], v[232:235], v[80:95]
    ds_read_b128 v[212:215], v14 offset:49152
    v_mfma_f32_32x32x16_bf16 v[144:159], v[220:223], v[236:239], v[144:159]
    ds_read_b128 v[196:199], v10 offset:20480
    s_waitcnt lgkmcnt(5)
    v_mfma_f32_32x32x16_bf16 v[96:111], v[224:227], v[232:235], v[96:111]
    ds_read_b128 v[200:203], v10 offset:24576
    v_mfma_f32_32x32x16_bf16 v[160:175], v[224:227], v[236:239], v[160:175]
    ds_read_b128 v[204:207], v10 offset:28672
    s_waitcnt lgkmcnt(6)
    v_mfma_f32_32x32x16_bf16 v[112:127], v[228:231], v[232:235], v[112:127]
    v_mfma_f32_32x32x16_bf16 v[176:191], v[228:231], v[236:239], v[176:191]
    s_barrier
    s_waitcnt lgkmcnt(4)
    v_mfma_f32_32x32x16_bf16 v[64:79], v[192:195], v[208:211], v[64:79]
    ds_read_b128 v[232:235], v15 offset:32768
    s_waitcnt lgkmcnt(4)
    v_mfma_f32_32x32x16_bf16 v[128:143], v[192:195], v[212:215], v[128:143]
    ds_read_b128 v[216:219], v11 offset:16384
    s_waitcnt lgkmcnt(4)
    v_mfma_f32_32x32x16_bf16 v[80:95], v[196:199], v[208:211], v[80:95]
    ds_read_b128 v[236:239], v15 offset:49152
    v_mfma_f32_32x32x16_bf16 v[144:159], v[196:199], v[212:215], v[144:159]
    ds_read_b128 v[220:223], v11 offset:20480
    s_waitcnt lgkmcnt(5)
    v_mfma_f32_32x32x16_bf16 v[96:111], v[200:203], v[208:211], v[96:111]
    ds_read_b128 v[224:227], v11 offset:24576
    v_mfma_f32_32x32x16_bf16 v[160:175], v[200:203], v[212:215], v[160:175]
    ds_read_b128 v[228:231], v11 offset:28672
    s_waitcnt lgkmcnt(6)
    v_mfma_f32_32x32x16_bf16 v[112:127], v[204:207], v[208:211], v[112:127]
    v_mfma_f32_32x32x16_bf16 v[176:191], v[204:207], v[212:215], v[176:191]
    s_waitcnt lgkmcnt(4)
    v_mfma_f32_32x32x16_bf16 v[64:79], v[216:219], v[232:235], v[64:79]
    ds_read_b128 v[208:211], v16 offset:32768
    s_waitcnt lgkmcnt(4)
    v_mfma_f32_32x32x16_bf16 v[128:143], v[216:219], v[236:239], v[128:143]
    ds_read_b128 v[192:195], v12 offset:16384
    s_waitcnt lgkmcnt(4)
    v_mfma_f32_32x32x16_bf16 v[80:95], v[220:223], v[232:235], v[80:95]
    ds_read_b128 v[212:215], v16 offset:49152
    v_mfma_f32_32x32x16_bf16 v[144:159], v[220:223], v[236:239], v[144:159]
    ds_read_b128 v[196:199], v12 offset:20480
    s_waitcnt lgkmcnt(5)
    v_mfma_f32_32x32x16_bf16 v[96:111], v[224:227], v[232:235], v[96:111]
    ds_read_b128 v[200:203], v12 offset:24576
    v_mfma_f32_32x32x16_bf16 v[160:175], v[224:227], v[236:239], v[160:175]
    ds_read_b128 v[204:207], v12 offset:28672
    s_waitcnt lgkmcnt(6)
    v_mfma_f32_32x32x16_bf16 v[112:127], v[228:231], v[232:235], v[112:127]
    v_mfma_f32_32x32x16_bf16 v[176:191], v[228:231], v[236:239], v[176:191]
    buffer_load_dword v4, v7, s[36:39], 0 offen sc1
    s_barrier
    s_waitcnt lgkmcnt(4)
    v_mfma_f32_32x32x16_bf16 v[64:79], v[192:195], v[208:211], v[64:79]
    ds_read_b128 v[232:235], v17 offset:32768
    s_waitcnt lgkmcnt(4)
    v_mfma_f32_32x32x16_bf16 v[128:143], v[192:195], v[212:215], v[128:143]
    ds_read_b128 v[216:219], v13 offset:16384
    s_waitcnt lgkmcnt(4)
    v_mfma_f32_32x32x16_bf16 v[80:95], v[196:199], v[208:211], v[80:95]
    ds_read_b128 v[236:239], v17 offset:49152
    v_mfma_f32_32x32x16_bf16 v[144:159], v[196:199], v[212:215], v[144:159]
    ds_read_b128 v[220:223], v13 offset:20480
    s_waitcnt lgkmcnt(5)
    v_mfma_f32_32x32x16_bf16 v[96:111], v[200:203], v[208:211], v[96:111]
    ds_read_b128 v[224:227], v13 offset:24576
    v_mfma_f32_32x32x16_bf16 v[160:175], v[200:203], v[212:215], v[160:175]
    ds_read_b128 v[228:231], v13 offset:28672
    s_waitcnt lgkmcnt(6)
    v_mfma_f32_32x32x16_bf16 v[112:127], v[204:207], v[208:211], v[112:127]
    v_mfma_f32_32x32x16_bf16 v[176:191], v[204:207], v[212:215], v[176:191]
    s_waitcnt lgkmcnt(4)
    v_mfma_f32_32x32x16_bf16 v[64:79], v[216:219], v[232:235], v[64:79]
    ds_read_b128 v[208:211], v18 offset:0
    s_waitcnt lgkmcnt(4)
    v_mfma_f32_32x32x16_bf16 v[128:143], v[216:219], v[236:239], v[128:143]
    ds_read_b128 v[192:195], v10 offset:32768
    s_waitcnt lgkmcnt(4)
    v_mfma_f32_32x32x16_bf16 v[80:95], v[220:223], v[232:235], v[80:95]
    ds_read_b128 v[212:215], v18 offset:16384
    v_mfma_f32_32x32x16_bf16 v[144:159], v[220:223], v[236:239], v[144:159]
    ds_read_b128 v[196:199], v10 offset:36864
    s_waitcnt lgkmcnt(5)
    v_mfma_f32_32x32x16_bf16 v[96:111], v[224:227], v[232:235], v[96:111]
    ds_read_b128 v[200:203], v10 offset:40960
    v_mfma_f32_32x32x16_bf16 v[160:175], v[224:227], v[236:239], v[160:175]
    ds_read_b128 v[204:207], v10 offset:45056
    s_waitcnt lgkmcnt(6)
    v_mfma_f32_32x32x16_bf16 v[112:127], v[228:231], v[232:235], v[112:127]
    v_mfma_f32_32x32x16_bf16 v[176:191], v[228:231], v[236:239], v[176:191]
    s_barrier
    s_waitcnt lgkmcnt(4)
    v_mfma_f32_32x32x16_bf16 v[64:79], v[192:195], v[208:211], v[64:79]
    ds_read_b128 v[232:235], v19 offset:0
    s_waitcnt lgkmcnt(4)
    v_mfma_f32_32x32x16_bf16 v[128:143], v[192:195], v[212:215], v[128:143]
    ds_read_b128 v[216:219], v11 offset:32768
    s_waitcnt lgkmcnt(4)
    v_mfma_f32_32x32x16_bf16 v[80:95], v[196:199], v[208:211], v[80:95]
    ds_read_b128 v[236:239], v19 offset:16384
    v_mfma_f32_32x32x16_bf16 v[144:159], v[196:199], v[212:215], v[144:159]
    ds_read_b128 v[220:223], v11 offset:36864
    s_waitcnt lgkmcnt(5)
    v_mfma_f32_32x32x16_bf16 v[96:111], v[200:203], v[208:211], v[96:111]
    ds_read_b128 v[224:227], v11 offset:40960
    v_mfma_f32_32x32x16_bf16 v[160:175], v[200:203], v[212:215], v[160:175]
    ds_read_b128 v[228:231], v11 offset:45056
    s_waitcnt lgkmcnt(6)
    v_mfma_f32_32x32x16_bf16 v[112:127], v[204:207], v[208:211], v[112:127]
    v_mfma_f32_32x32x16_bf16 v[176:191], v[204:207], v[212:215], v[176:191]
    s_waitcnt lgkmcnt(4)
    v_mfma_f32_32x32x16_bf16 v[64:79], v[216:219], v[232:235], v[64:79]
    ds_read_b128 v[208:211], v20 offset:0
    s_waitcnt lgkmcnt(4)
    v_mfma_f32_32x32x16_bf16 v[128:143], v[216:219], v[236:239], v[128:143]
    ds_read_b128 v[192:195], v12 offset:32768
    s_waitcnt lgkmcnt(4)
    v_mfma_f32_32x32x16_bf16 v[80:95], v[220:223], v[232:235], v[80:95]
    ds_read_b128 v[212:215], v20 offset:16384
    v_mfma_f32_32x32x16_bf16 v[144:159], v[220:223], v[236:239], v[144:159]
    ds_read_b128 v[196:199], v12 offset:36864
    s_waitcnt lgkmcnt(5)
    v_mfma_f32_32x32x16_bf16 v[96:111], v[224:227], v[232:235], v[96:111]
    ds_read_b128 v[200:203], v12 offset:40960
    v_mfma_f32_32x32x16_bf16 v[160:175], v[224:227], v[236:239], v[160:175]
    ds_read_b128 v[204:207], v12 offset:45056
    s_waitcnt lgkmcnt(6)
    v_mfma_f32_32x32x16_bf16 v[112:127], v[228:231], v[232:235], v[112:127]
    v_mfma_f32_32x32x16_bf16 v[176:191], v[228:231], v[236:239], v[176:191]
    s_waitcnt vmcnt(0)
    s_barrier
    s_cmp_lg_u32 s40, 0
    s_cbranch_scc1 GF_24
    s_mov_b32 s42, 0
    s_branch NCK_27
NTA_26:
    s_waitcnt vmcnt(0)
NCK_27:
    v_readfirstlane_b32 s98, v4
    s_nop 3
    s_cmp_lg_u32 s98, 0
    s_cbranch_scc1 NFA_25
    s_add_u32 s42, s42, 1
    s_cmp_ge_u32 s42, 0x40000
    s_cbranch_scc1 NFA_25
    s_sleep 1
    buffer_load_dword v4, v7, s[36:39], 0 offen sc1
    s_branch NTA_26
NFA_25:
    s_add_u32 s99, s99, 128
    v_mov_b32 v60, s98
    v_lshlrev_b32 v61, 24, v1
    v_add_u32 v61, s99, v61
    buffer_store_dword v60, v61, s[20:23], 0 offen sc1
    s_sub_u32 s99, s99, 128
GF_24:
    s_waitcnt lgkmcnt(4)
    v_mfma_f32_32x32x16_bf16 v[64:79], v[192:195], v[208:211], v[64:79]
    ds_read_b128 v[232:235], v21 offset:0
    s_waitcnt lgkmcnt(4)
    v_mfma_f32_32x32x16_bf16 v[128:143], v[192:195], v[212:215], v[128:143]
    ds_read_b128 v[216:219], v13 offset:32768
    s_waitcnt lgkmcnt(4)
    v_mfma_f32_32x32x16_bf16 v[80:95], v[196:199], v[208:211], v[80:95]
    ds_read_b128 v[236:239], v21 offset:16384
    v_mfma_f32_32x32x16_bf16 v[144:159], v[196:199], v[212:215], v[144:159]
    ds_read_b128 v[220:223], v13 offset:36864
    s_waitcnt lgkmcnt(5)
    v_mfma_f32_32x32x16_bf16 v[96:111], v[200:203], v[208:211], v[96:111]
    ds_read_b128 v[224:227], v13 offset:40960
    v_mfma_f32_32x32x16_bf16 v[160:175], v[200:203], v[212:215], v[160:175]
    ds_read_b128 v[228:231], v13 offset:45056
    s_waitcnt lgkmcnt(6)
    v_mfma_f32_32x32x16_bf16 v[112:127], v[204:207], v[208:211], v[112:127]
    v_mfma_f32_32x32x16_bf16 v[176:191], v[204:207], v[212:215], v[176:191]
    s_waitcnt lgkmcnt(4)
    v_mfma_f32_32x32x16_bf16 v[64:79], v[216:219], v[232:235], v[64:79]
    ds_read_b128 v[208:211], v14 offset:0
    s_waitcnt lgkmcnt(4)
    v_mfma_f32_32x32x16_bf16 v[128:143], v[216:219], v[236:239], v[128:143]
    ds_read_b128 v[192:195], v10 offset:49152
    s_waitcnt lgkmcnt(4)
    v_mfma_f32_32x32x16_bf16 v[80:95], v[220:223], v[232:235], v[80:95]
    ds_read_b128 v[212:215], v14 offset:16384
    v_mfma_f32_32x32x16_bf16 v[144:159], v[220:223], v[236:239], v[144:159]
    ds_read_b128 v[196:199], v10 offset:53248
    s_waitcnt lgkmcnt(5)
    v_mfma_f32_32x32x16_bf16 v[96:111], v[224:227], v[232:235], v[96:111]
    ds_read_b128 v[200:203], v10 offset:57344
    v_mfma_f32_32x32x16_bf16 v[160:175], v[224:227], v[236:239], v[160:175]
    ds_read_b128 v[204:207], v10 offset:61440
    s_waitcnt lgkmcnt(6)
    v_mfma_f32_32x32x16_bf16 v[112:127], v[228:231], v[232:235], v[112:127]
    v_mfma_f32_32x32x16_bf16 v[176:191], v[228:231], v[236:239], v[176:191]
    s_barrier
    s_waitcnt lgkmcnt(4)
    v_mfma_f32_32x32x16_bf16 v[64:79], v[192:195], v[208:211], v[64:79]
    ds_read_b128 v[232:235], v15 offset:0
    s_waitcnt lgkmcnt(4)
    v_mfma_f32_32x32x16_bf16 v[128:143], v[192:195], v[212:215], v[128:143]
    ds_read_b128 v[216:219], v11 offset:49152
    s_waitcnt lgkmcnt(4)
    v_mfma_f32_32x32x16_bf16 v[80:95], v[196:199], v[208:211], v[80:95]
    ds_read_b128 v[236:239], v15 offset:16384
    v_mfma_f32_32x32x16_bf16 v[144:159], v[196:199], v[212:215], v[144:159]
    ds_read_b128 v[220:223], v11 offset:53248
    s_waitcnt lgkmcnt(5)
    v_mfma_f32_32x32x16_bf16 v[96:111], v[200:203], v[208:211], v[96:111]
    ds_read_b128 v[224:227], v11 offset:57344
    v_mfma_f32_32x32x16_bf16 v[160:175], v[200:203], v[212:215], v[160:175]
    ds_read_b128 v[228:231], v11 offset:61440
    s_waitcnt lgkmcnt(6)
    v_mfma_f32_32x32x16_bf16 v[112:127], v[204:207], v[208:211], v[112:127]
    v_mfma_f32_32x32x16_bf16 v[176:191], v[204:207], v[212:215], v[176:191]
    s_waitcnt lgkmcnt(4)
    v_mfma_f32_32x32x16_bf16 v[64:79], v[216:219], v[232:235], v[64:79]
    ds_read_b128 v[208:211], v16 offset:0
    s_waitcnt lgkmcnt(4)
    v_mfma_f32_32x32x16_bf16 v[128:143], v[216:219], v[236:239], v[128:143]
    ds_read_b128 v[192:195], v12 offset:49152
    s_waitcnt lgkmcnt(4)
    v_mfma_f32_32x32x16_bf16 v[80:95], v[220:223], v[232:235], v[80:95]
    ds_read_b128 v[212:215], v16 offset:16384
    v_mfma_f32_32x32x16_bf16 v[144:159], v[220:223], v[236:239], v[144:159]
    ds_read_b128 v[196:199], v12 offset:53248
    s_waitcnt lgkmcnt(5)
    v_mfma_f32_32x32x16_bf16 v[96:111], v[224:227], v[232:235], v[96:111]
    ds_read_b128 v[200:203], v12 offset:57344
    v_mfma_f32_32x32x16_bf16 v[160:175], v[224:227], v[236:239], v[160:175]
    ds_read_b128 v[204:207], v12 offset:61440
    s_waitcnt lgkmcnt(6)
    v_mfma_f32_32x32x16_bf16 v[112:127], v[228:231], v[232:235], v[112:127]
    v_mfma_f32_32x32x16_bf16 v[176:191], v[228:231], v[236:239], v[176:191]
    s_barrier
    s_waitcnt lgkmcnt(4)
    v_mfma_f32_32x32x16_bf16 v[64:79], v[192:195], v[208:211], v[64:79]
    ds_read_b128 v[232:235], v17 offset:0
    s_waitcnt lgkmcnt(4)
    v_mfma_f32_32x32x16_bf16 v[128:143], v[192:195], v[212:215], v[128:143]
    ds_read_b128 v[216:219], v13 offset:49152
    s_waitcnt lgkmcnt(4)
    v_mfma_f32_32x32x16_bf16 v[80:95], v[196:199], v[208:211], v[80:95]
    ds_read_b128 v[236:239], v17 offset:16384
    v_mfma_f32_32x32x16_bf16 v[144:159], v[196:199], v[212:215], v[144:159]
    ds_read_b128 v[220:223], v13 offset:53248
    s_waitcnt lgkmcnt(5)
    v_mfma_f32_32x32x16_bf16 v[96:111], v[200:203], v[208:211], v[96:111]
    ds_read_b128 v[224:227], v13 offset:57344
    v_mfma_f32_32x32x16_bf16 v[160:175], v[200:203], v[212:215], v[160:175]
    ds_read_b128 v[228:231], v13 offset:61440
    s_waitcnt lgkmcnt(6)
    v_mfma_f32_32x32x16_bf16 v[112:127], v[204:207], v[208:211], v[112:127]
    v_mfma_f32_32x32x16_bf16 v[176:191], v[204:207], v[212:215], v[176:191]
    s_waitcnt lgkmcnt(4)
    v_mfma_f32_32x32x16_bf16 v[64:79], v[216:219], v[232:235], v[64:79]
    ds_read_b128 v[208:211], v14 offset:32768
    s_waitcnt lgkmcnt(4)
    v_mfma_f32_32x32x16_bf16 v[128:143], v[216:219], v[236:239], v[128:143]
    ds_read_b128 v[192:195], v10 offset:0
    s_waitcnt lgkmcnt(4)
    v_mfma_f32_32x32x16_bf16 v[80:95], v[220:223], v[232:235], v[80:95]
    ds_read_b128 v[212:215], v14 offset:49152
    v_mfma_f32_32x32x16_bf16 v[144:159], v[220:223], v[236:239], v[144:159]
    ds_read_b128 v[196:199], v10 offset:4096
    s_waitcnt lgkmcnt(5)
    v_mfma_f32_32x32x16_bf16 v[96:111], v[224:227], v[232:235], v[96:111]
    ds_read_b128 v[200:203], v10 offset:8192
    v_mfma_f32_32x32x16_bf16 v[160:175], v[224:227], v[236:239], v[160:175]
    ds_read_b128 v[204:207], v10 offset:12288
    s_waitcnt lgkmcnt(6)
    v_mfma_f32_32x32x16_bf16 v[112:127], v[228:231], v[232:235], v[112:127]
    v_mfma_f32_32x32x16_bf16 v[176:191], v[228:231], v[236:239], v[176:191]
    s_barrier
    s_waitcnt lgkmcnt(4)
    v_mfma_f32_32x32x16_bf16 v[64:79], v[192:195], v[208:211], v[64:79]
    ds_read_b128 v[232:235], v15 offset:32768
    s_waitcnt lgkmcnt(4)
    v_mfma_f32_32x32x16_bf16 v[128:143], v[192:195], v[212:215], v[128:143]
    ds_read_b128 v[216:219], v11 offset:0
    s_waitcnt lgkmcnt(4)
    v_mfma_f32_32x32x16_bf16 v[80:95], v[196:199], v[208:211], v[80:95]
    ds_read_b128 v[236:239], v15 offset:49152
    v_mfma_f32_32x32x16_bf16 v[144:159], v[196:199], v[212:215], v[144:159]
    ds_read_b128 v[220:223], v11 offset:4096
    s_waitcnt lgkmcnt(5)
    v_mfma_f32_32x32x16_bf16 v[96:111], v[200:203], v[208:211], v[96:111]
    ds_read_b128 v[224:227], v11 offset:8192
    v_mfma_f32_32x32x16_bf16 v[160:175], v[200:203], v[212:215], v[160:175]
    ds_read_b128 v[228:231], v11 offset:12288
    s_waitcnt lgkmcnt(6)
    v_mfma_f32_32x32x16_bf16 v[112:127], v[204:207], v[208:211], v[112:127]
    v_mfma_f32_32x32x16_bf16 v[176:191], v[204:207], v[212:215], v[176:191]
    s_waitcnt lgkmcnt(4)
    v_mfma_f32_32x32x16_bf16 v[64:79], v[216:219], v[232:235], v[64:79]
    ds_read_b128 v[208:211], v16 offset:32768
    s_waitcnt lgkmcnt(4)
    v_mfma_f32_32x32x16_bf16 v[128:143], v[216:219], v[236:239], v[128:143]
    ds_read_b128 v[192:195], v12 offset:0
    s_waitcnt lgkmcnt(4)
    v_mfma_f32_32x32x16_bf16 v[80:95], v[220:223], v[232:235], v[80:95]
    ds_read_b128 v[212:215], v16 offset:49152
    v_mfma_f32_32x32x16_bf16 v[144:159], v[220:223], v[236:239], v[144:159]
    ds_read_b128 v[196:199], v12 offset:4096
    s_waitcnt lgkmcnt(5)
    v_mfma_f32_32x32x16_bf16 v[96:111], v[224:227], v[232:235], v[96:111]
    ds_read_b128 v[200:203], v12 offset:8192
    v_mfma_f32_32x32x16_bf16 v[160:175], v[224:227], v[236:239], v[160:175]
    ds_read_b128 v[204:207], v12 offset:12288
    s_waitcnt lgkmcnt(6)
    v_mfma_f32_32x32x16_bf16 v[112:127], v[228:231], v[232:235], v[112:127]
    v_mfma_f32_32x32x16_bf16 v[176:191], v[228:231], v[236:239], v[176:191]
    s_barrier
    s_waitcnt lgkmcnt(4)
    v_mfma_f32_32x32x16_bf16 v[64:79], v[192:195], v[208:211], v[64:79]
    ds_read_b128 v[232:235], v17 offset:32768
    s_waitcnt lgkmcnt(4)
    v_mfma_f32_32x32x16_bf16 v[128:143], v[192:195], v[212:215], v[128:143]
    ds_read_b128 v[216:219], v13 offset:0
    s_waitcnt lgkmcnt(4)
    v_mfma_f32_32x32x16_bf16 v[80:95], v[196:199], v[208:211], v[80:95]
    ds_read_b128 v[236:239], v17 offset:49152
    v_mfma_f32_32x32x16_bf16 v[144:159], v[196:199], v[212:215], v[144:159]
    ds_read_b128 v[220:223], v13 offset:4096
    s_waitcnt lgkmcnt(5)
    v_mfma_f32_32x32x16_bf16 v[96:111], v[200:203], v[208:211], v[96:111]
    ds_read_b128 v[224:227], v13 offset:8192
    v_mfma_f32_32x32x16_bf16 v[160:175], v[200:203], v[212:215], v[160:175]
    ds_read_b128 v[228:231], v13 offset:12288
    s_waitcnt lgkmcnt(6)
    v_mfma_f32_32x32x16_bf16 v[112:127], v[204:207], v[208:211], v[112:127]
    v_mfma_f32_32x32x16_bf16 v[176:191], v[204:207], v[212:215], v[176:191]
    s_waitcnt lgkmcnt(4)
    v_mfma_f32_32x32x16_bf16 v[64:79], v[216:219], v[232:235], v[64:79]
    ds_read_b128 v[208:211], v18 offset:0
    s_waitcnt lgkmcnt(4)
    v_mfma_f32_32x32x16_bf16 v[128:143], v[216:219], v[236:239], v[128:143]
    ds_read_b128 v[192:195], v10 offset:16384
    s_waitcnt lgkmcnt(4)
    v_mfma_f32_32x32x16_bf16 v[80:95], v[220:223], v[232:235], v[80:95]
    ds_read_b128 v[212:215], v18 offset:16384
    v_mfma_f32_32x32x16_bf16 v[144:159], v[220:223], v[236:239], v[144:159]
    ds_read_b128 v[196:199], v10 offset:20480
    s_waitcnt lgkmcnt(5)
    v_mfma_f32_32x32x16_bf16 v[96:111], v[224:227], v[232:235], v[96:111]
    ds_read_b128 v[200:203], v10 offset:24576
    v_mfma_f32_32x32x16_bf16 v[160:175], v[224:227], v[236:239], v[160:175]
    ds_read_b128 v[204:207], v10 offset:28672
    s_waitcnt lgkmcnt(6)
    v_mfma_f32_32x32x16_bf16 v[112:127], v[228:231], v[232:235], v[112:127]
    v_mfma_f32_32x32x16_bf16 v[176:191], v[228:231], v[236:239], v[176:191]
    s_barrier
    s_waitcnt lgkmcnt(4)
    v_mfma_f32_32x32x16_bf16 v[64:79], v[192:195], v[208:211], v[64:79]
    ds_read_b128 v[232:235], v19 offset:0
    s_waitcnt lgkmcnt(4)
    v_mfma_f32_32x32x16_bf16 v[128:143], v[192:195], v[212:215], v[128:143]
    ds_read_b128 v[216:219], v11 offset:16384
    s_waitcnt lgkmcnt(4)
    v_mfma_f32_32x32x16_bf16 v[80:95], v[196:199], v[208:211], v[80:95]
    ds_read_b128 v[236:239], v19 offset:16384
    v_mfma_f32_32x32x16_bf16 v[144:159], v[196:199], v[212:215], v[144:159]
    ds_read_b128 v[220:223], v11 offset:20480
    s_waitcnt lgkmcnt(5)
    v_mfma_f32_32x32x16_bf16 v[96:111], v[200:203], v[208:211], v[96:111]
    ds_read_b128 v[224:227], v11 offset:24576
    v_mfma_f32_32x32x16_bf16 v[160:175], v[200:203], v[212:215], v[160:175]
    ds_read_b128 v[228:231], v11 offset:28672
    s_waitcnt lgkmcnt(6)
    v_mfma_f32_32x32x16_bf16 v[112:127], v[204:207], v[208:211], v[112:127]
    v_mfma_f32_32x32x16_bf16 v[176:191], v[204:207], v[212:215], v[176:191]
    s_waitcnt lgkmcnt(4)
    v_mfma_f32_32x32x16_bf16 v[64:79], v[216:219], v[232:235], v[64:79]
    ds_read_b128 v[208:211], v20 offset:0
    s_waitcnt lgkmcnt(4)
    v_mfma_f32_32x32x16_bf16 v[128:143], v[216:219], v[236:239], v[128:143]
    ds_read_b128 v[192:195], v12 offset:16384
    s_waitcnt lgkmcnt(4)
    v_mfma_f32_32x32x16_bf16 v[80:95], v[220:223], v[232:235], v[80:95]
    ds_read_b128 v[212:215], v20 offset:16384
    v_mfma_f32_32x32x16_bf16 v[144:159], v[220:223], v[236:239], v[144:159]
    ds_read_b128 v[196:199], v12 offset:20480
    s_waitcnt lgkmcnt(5)
    v_mfma_f32_32x32x16_bf16 v[96:111], v[224:227], v[232:235], v[96:111]
    ds_read_b128 v[200:203], v12 offset:24576
    v_mfma_f32_32x32x16_bf16 v[160:175], v[224:227], v[236:239], v[160:175]
    ds_read_b128 v[204:207], v12 offset:28672
    s_waitcnt lgkmcnt(6)
    v_mfma_f32_32x32x16_bf16 v[112:127], v[228:231], v[232:235], v[112:127]
    v_mfma_f32_32x32x16_bf16 v[176:191], v[228:231], v[236:239], v[176:191]
    s_barrier
    buffer_load_dword v4, v7, s[36:39], 0 offen sc1
    s_waitcnt lgkmcnt(4)
    v_mfma_f32_32x32x16_bf16 v[64:79], v[192:195], v[208:211], v[64:79]
    ds_read_b128 v[232:235], v21 offset:0
    s_waitcnt lgkmcnt(4)
    v_mfma_f32_32x32x16_bf16 v[128:143], v[192:195], v[212:215], v[128:143]
    ds_read_b128 v[216:219], v13 offset:16384
    s_waitcnt lgkmcnt(4)
    v_mfma_f32_32x32x16_bf16 v[80:95], v[196:199], v[208:211], v[80:95]
    ds_read_b128 v[236:239], v21 offset:16384
    v_mfma_f32_32x32x16_bf16 v[144:159], v[196:199], v[212:215], v[144:159]
    ds_read_b128 v[220:223], v13 offset:20480
    s_waitcnt lgkmcnt(5)
    v_mfma_f32_32x32x16_bf16 v[96:111], v[200:203], v[208:211], v[96:111]
    ds_read_b128 v[224:227], v13 offset:24576
    v_mfma_f32_32x32x16_bf16 v[160:175], v[200:203], v[212:215], v[160:175]
    ds_read_b128 v[228:231], v13 offset:28672
    s_waitcnt lgkmcnt(6)
    v_mfma_f32_32x32x16_bf16 v[112:127], v[204:207], v[208:211], v[112:127]
    v_mfma_f32_32x32x16_bf16 v[176:191], v[204:207], v[212:215], v[176:191]
    s_waitcnt lgkmcnt(4)
    v_mfma_f32_32x32x16_bf16 v[64:79], v[216:219], v[232:235], v[64:79]
    ds_read_b128 v[208:211], v14 offset:0
    s_waitcnt lgkmcnt(4)
    v_mfma_f32_32x32x16_bf16 v[128:143], v[216:219], v[236:239], v[128:143]
    ds_read_b128 v[192:195], v10 offset:32768
    s_waitcnt lgkmcnt(4)
    v_mfma_f32_32x32x16_bf16 v[80:95], v[220:223], v[232:235], v[80:95]
    ds_read_b128 v[212:215], v14 offset:16384
    v_mfma_f32_32x32x16_bf16 v[144:159], v[220:223], v[236:239], v[144:159]
    ds_read_b128 v[196:199], v10 offset:36864
    s_waitcnt lgkmcnt(5)
    v_mfma_f32_32x32x16_bf16 v[96:111], v[224:227], v[232:235], v[96:111]
    ds_read_b128 v[200:203], v10 offset:40960
    v_mfma_f32_32x32x16_bf16 v[160:175], v[224:227], v[236:239], v[160:175]
    ds_read_b128 v[204:207], v10 offset:45056
    s_waitcnt lgkmcnt(6)
    v_mfma_f32_32x32x16_bf16 v[112:127], v[228:231], v[232:235], v[112:127]
    v_mfma_f32_32x32x16_bf16 v[176:191], v[228:231], v[236:239], v[176:191]
    s_barrier
    s_waitcnt lgkmcnt(4)
    v_mfma_f32_32x32x16_bf16 v[64:79], v[192:195], v[208:211], v[64:79]
    ds_read_b128 v[232:235], v15 offset:0
    s_waitcnt lgkmcnt(4)
    v_mfma_f32_32x32x16_bf16 v[128:143], v[192:195], v[212:215], v[128:143]
    ds_read_b128 v[216:219], v11 offset:32768
    s_waitcnt lgkmcnt(4)
    v_mfma_f32_32x32x16_bf16 v[80:95], v[196:199], v[208:211], v[80:95]
    ds_read_b128 v[236:239], v15 offset:16384
    v_mfma_f32_32x32x16_bf16 v[144:159], v[196:199], v[212:215], v[144:159]
    ds_read_b128 v[220:223], v11 offset:36864
    s_waitcnt lgkmcnt(5)
    v_mfma_f32_32x32x16_bf16 v[96:111], v[200:203], v[208:211], v[96:111]
    ds_read_b128 v[224:227], v11 offset:40960
    v_mfma_f32_32x32x16_bf16 v[160:175], v[200:203], v[212:215], v[160:175]
    ds_read_b128 v[228:231], v11 offset:45056
    s_waitcnt lgkmcnt(6)
    v_mfma_f32_32x32x16_bf16 v[112:127], v[204:207], v[208:211], v[112:127]
    v_mfma_f32_32x32x16_bf16 v[176:191], v[204:207], v[212:215], v[176:191]
    s_waitcnt lgkmcnt(4)
    v_mfma_f32_32x32x16_bf16 v[64:79], v[216:219], v[232:235], v[64:79]
    ds_read_b128 v[208:211], v16 offset:0
    s_waitcnt lgkmcnt(4)
    v_mfma_f32_32x32x16_bf16 v[128:143], v[216:219], v[236:239], v[128:143]
    ds_read_b128 v[192:195], v12 offset:32768
    s_waitcnt lgkmcnt(4)
    v_mfma_f32_32x32x16_bf16 v[80:95], v[220:223], v[232:235], v[80:95]
    ds_read_b128 v[212:215], v16 offset:16384
    v_mfma_f32_32x32x16_bf16 v[144:159], v[220:223], v[236:239], v[144:159]
    ds_read_b128 v[196:199], v12 offset:36864
    s_waitcnt lgkmcnt(5)
    v_mfma_f32_32x32x16_bf16 v[96:111], v[224:227], v[232:235], v[96:111]
    ds_read_b128 v[200:203], v12 offset:40960
    v_mfma_f32_32x32x16_bf16 v[160:175], v[224:227], v[236:239], v[160:175]
    ds_read_b128 v[204:207], v12 offset:45056
    s_waitcnt lgkmcnt(6)
    v_mfma_f32_32x32x16_bf16 v[112:127], v[228:231], v[232:235], v[112:127]
    v_mfma_f32_32x32x16_bf16 v[176:191], v[228:231], v[236:239], v[176:191]
    s_barrier
    s_waitcnt lgkmcnt(4)
    v_mfma_f32_32x32x16_bf16 v[64:79], v[192:195], v[208:211], v[64:79]
    ds_read_b128 v[232:235], v17 offset:0
    s_waitcnt lgkmcnt(4)
    v_mfma_f32_32x32x16_bf16 v[128:143], v[192:195], v[212:215], v[128:143]
    ds_read_b128 v[216:219], v13 offset:32768
    s_waitcnt lgkmcnt(4)
    v_mfma_f32_32x32x16_bf16 v[80:95], v[196:199], v[208:211], v[80:95]
    ds_read_b128 v[236:239], v17 offset:16384
    v_mfma_f32_32x32x16_bf16 v[144:159], v[196:199], v[212:215], v[144:159]
    ds_read_b128 v[220:223], v13 offset:36864
    s_waitcnt lgkmcnt(5)
    v_mfma_f32_32x32x16_bf16 v[96:111], v[200:203], v[208:211], v[96:111]
    ds_read_b128 v[224:227], v13 offset:40960
    v_mfma_f32_32x32x16_bf16 v[160:175], v[200:203], v[212:215], v[160:175]
    ds_read_b128 v[228:231], v13 offset:45056
    s_waitcnt lgkmcnt(6)
    v_mfma_f32_32x32x16_bf16 v[112:127], v[204:207], v[208:211], v[112:127]
    v_mfma_f32_32x32x16_bf16 v[176:191], v[204:207], v[212:215], v[176:191]
    s_waitcnt lgkmcnt(4)
    v_mfma_f32_32x32x16_bf16 v[64:79], v[216:219], v[232:235], v[64:79]
    s_waitcnt lgkmcnt(3)
    v_mfma_f32_32x32x16_bf16 v[128:143], v[216:219], v[236:239], v[128:143]
    s_waitcnt lgkmcnt(2)
    v_mfma_f32_32x32x16_bf16 v[80:95], v[220:223], v[232:235], v[80:95]
    v_mfma_f32_32x32x16_bf16 v[144:159], v[220:223], v[236:239], v[144:159]
    s_waitcnt lgkmcnt(1)
    v_mfma_f32_32x32x16_bf16 v[96:111], v[224:227], v[232:235], v[96:111]
    v_mfma_f32_32x32x16_bf16 v[160:175], v[224:227], v[236:239], v[160:175]
    s_waitcnt lgkmcnt(0)
    v_mfma_f32_32x32x16_bf16 v[112:127], v[228:231], v[232:235], v[112:127]
    v_mfma_f32_32x32x16_bf16 v[176:191], v[228:231], v[236:239], v[176:191]
    s_mov_b32 s42, 0
NTA_29:
    s_waitcnt vmcnt(0)
NCK_30:
    v_readfirstlane_b32 s98, v4
    s_nop 3
    s_cmp_lg_u32 s98, 0
    s_cbranch_scc1 NFA_28
    s_add_u32 s42, s42, 1
    s_cmp_ge_u32 s42, 0x40000
    s_cbranch_scc1 NFA_28
    s_sleep 1
    buffer_load_dword v4, v7, s[36:39], 0 offen sc1
    s_branch NTA_29
NFA_28:
    s_nop 7
    s_nop 3
    v_cvt_pk_bf16_f32 v192, v64, v65
    v_cvt_pk_bf16_f32 v200, v128, v129
    v_cvt_pk_bf16_f32 v193, v66, v67
    v_cvt_pk_bf16_f32 v201, v130, v131
    v_cvt_pk_bf16_f32 v194, v68, v69
    v_cvt_pk_bf16_f32 v202, v132, v133
    v_cvt_pk_bf16_f32 v195, v70, v71
    v_cvt_pk_bf16_f32 v203, v134, v135
    v_cvt_pk_bf16_f32 v196, v72, v73
    v_cvt_pk_bf16_f32 v204, v136, v137
    v_cvt_pk_bf16_f32 v197, v74, v75
    v_cvt_pk_bf16_f32 v205, v138, v139
    v_cvt_pk_bf16_f32 v198, v76, v77
    v_cvt_pk_bf16_f32 v206, v140, v141
    v_cvt_pk_bf16_f32 v199, v78, v79
    v_cvt_pk_bf16_f32 v207, v142, v143
    v_cvt_pk_bf16_f32 v208, v80, v81
    v_cvt_pk_bf16_f32 v216, v144, v145
    v_cvt_pk_bf16_f32 v209, v82, v83
    v_cvt_pk_bf16_f32 v217, v146, v147
    v_cvt_pk_bf16_f32 v210, v84, v85
    v_cvt_pk_bf16_f32 v218, v148, v149
    v_cvt_pk_bf16_f32 v211, v86, v87
    v_cvt_pk_bf16_f32 v219, v150, v151
    v_cvt_pk_bf16_f32 v212, v88, v89
    v_cvt_pk_bf16_f32 v220, v152, v153
    v_cvt_pk_bf16_f32 v213, v90, v91
    v_cvt_pk_bf16_f32 v221, v154, v155
    v_cvt_pk_bf16_f32 v214, v92, v93
    v_cvt_pk_bf16_f32 v222, v156, v157
    v_cvt_pk_bf16_f32 v215, v94, v95
    v_cvt_pk_bf16_f32 v223, v158, v159
    v_cvt_pk_bf16_f32 v224, v96, v97
    v_cvt_pk_bf16_f32 v232, v160, v161
    v_cvt_pk_bf16_f32 v225, v98, v99
    v_cvt_pk_bf16_f32 v233, v162, v163
    v_cvt_pk_bf16_f32 v226, v100, v101
    v_cvt_pk_bf16_f32 v234, v164, v165
    v_cvt_pk_bf16_f32 v227, v102, v103
    v_cvt_pk_bf16_f32 v235, v166, v167
    v_cvt_pk_bf16_f32 v228, v104, v105
    v_cvt_pk_bf16_f32 v236, v168, v169
    v_cvt_pk_bf16_f32 v229, v106, v107
    v_cvt_pk_bf16_f32 v237, v170, v171
    v_cvt_pk_bf16_f32 v230, v108, v109
    v_cvt_pk_bf16_f32 v238, v172, v173
    v_cvt_pk_bf16_f32 v231, v110, v111
    v_cvt_pk_bf16_f32 v239, v174, v175
    v_cvt_pk_bf16_f32 v240, v112, v113
    v_cvt_pk_bf16_f32 v248, v176, v177
    v_cvt_pk_bf16_f32 v241, v114, v115
    v_cvt_pk_bf16_f32 v249, v178, v179
    v_cvt_pk_bf16_f32 v242, v116, v117
    v_cvt_pk_bf16_f32 v250, v180, v181
    v_cvt_pk_bf16_f32 v243, v118, v119
    v_cvt_pk_bf16_f32 v251, v182, v183
    v_cvt_pk_bf16_f32 v244, v120, v121
    v_cvt_pk_bf16_f32 v252, v184, v185
    v_cvt_pk_bf16_f32 v245, v122, v123
    v_cvt_pk_bf16_f32 v253, v186, v187
    v_cvt_pk_bf16_f32 v246, v124, v125
    v_cvt_pk_bf16_f32 v254, v188, v189
    v_cvt_pk_bf16_f32 v247, v126, v127
    v_cvt_pk_bf16_f32 v255, v190, v191
    s_barrier
    v_lshlrev_b32 v2, 4, v1
    ds_read_b128 v[10:13], v2 offset:0
    ds_read_b128 v[14:17], v2 offset:1024
    ds_read_b128 v[18:21], v2 offset:2048
    ds_read_b128 v[22:25], v2 offset:3072
    ds_read_b128 v[26:29], v2 offset:4096
    ds_read_b128 v[30:33], v2 offset:5120
    ds_read_b128 v[34:37], v2 offset:6144
    ds_read_b128 v[38:41], v2 offset:7168
    ds_read_b128 v[42:45], v2 offset:8192
    ds_read_b128 v[46:49], v2 offset:9216
    ds_read_b128 v[50:53], v2 offset:10240
    ds_read_b128 v[54:57], v2 offset:11264
    s_waitcnt lgkmcnt(6)
    v_mfma_f32_32x32x16_bf16 v[64:79], v[10:13], v[192:195], 0
    v_mfma_f32_32x32x16_bf16 v[128:143], v[10:13], v[200:203], 0
    v_mfma_f32_32x32x16_bf16 v[64:79], v[14:17], v[196:199], v[64:79]
    v_mfma_f32_32x32x16_bf16 v[128:143], v[14:17], v[204:207], v[128:143]
    v_mfma_f32_32x32x16_bf16 v[64:79], v[18:21], v[200:203], v[64:79]
    v_mfma_f32_32x32x16_bf16 v[128:143], v[26:29], v[192:195], v[128:143]
    v_mfma_f32_32x32x16_bf16 v[64:79], v[22:25], v[204:207], v[64:79]
    v_mfma_f32_32x32x16_bf16 v[128:143], v[30:33], v[196:199], v[128:143]
    ds_read_b128 v[10:13], v2 offset:12288
    ds_read_b128 v[14:17], v2 offset:13312
    ds_read_b128 v[18:21], v2 offset:14336
    ds_read_b128 v[22:25], v2 offset:15360
    ds_read_b128 v[26:29], v2 offset:16384
    ds_read_b128 v[30:33], v2 offset:17408
    s_waitcnt lgkmcnt(6)
    v_mfma_f32_32x32x16_bf16 v[80:95], v[34:37], v[208:211], 0
    v_mfma_f32_32x32x16_bf16 v[144:159], v[34:37], v[216:219], 0
    v_mfma_f32_32x32x16_bf16 v[80:95], v[38:41], v[212:215], v[80:95]
    v_mfma_f32_32x32x16_bf16 v[144:159], v[38:41], v[220:223], v[144:159]
    v_mfma_f32_32x32x16_bf16 v[80:95], v[42:45], v[216:219], v[80:95]
    v_mfma_f32_32x32x16_bf16 v[144:159], v[50:53], v[208:211], v[144:159]
    v_mfma_f32_32x32x16_bf16 v[80:95], v[46:49], v[220:223], v[80:95]
    v_mfma_f32_32x32x16_bf16 v[144:159], v[54:57], v[212:215], v[144:159]
    ds_read_b128 v[34:37], v2 offset:18432
    ds_read_b128 v[38:41], v2 offset:19456
    ds_read_b128 v[42:45], v2 offset:20480
    ds_read_b128 v[46:49], v2 offset:21504
    ds_read_b128 v[50:53], v2 offset:22528
    ds_read_b128 v[54:57], v2 offset:23552
    s_waitcnt lgkmcnt(6)
    v_mfma_f32_32x32x16_bf16 v[96:111], v[10:13], v[224:227], 0
    v_mfma_f32_32x32x16_bf16 v[160:175], v[10:13], v[232:235], 0
    v_mfma_f32_32x32x16_bf16 v[96:111], v[14:17], v[228:231], v[96:111]
    v_mfma_f32_32x32x16_bf16 v[160:175], v[14:17], v[236:239], v[160:175]
    v_mfma_f32_32x32x16_bf16 v[96:111], v[18:21], v[232:235], v[96:111]
    v_mfma_f32_32x32x16_bf16 v[160:175], v[26:29], v[224:227], v[160:175]
    v_mfma_f32_32x32x16_bf16 v[96:111], v[22:25], v[236:239], v[96:111]
    v_mfma_f32_32x32x16_bf16 v[160:175], v[30:33], v[228:231], v[160:175]
    s_waitcnt lgkmcnt(0)
    v_mfma_f32_32x32x16_bf16 v[112:127], v[34:37], v[240:243], 0
    v_mfma_f32_32x32x16_bf16 v[176:191], v[34:37], v[248:251], 0
    v_mfma_f32_32x32x16_bf16 v[112:127], v[38:41], v[244:247], v[112:127]
    v_mfma_f32_32x32x16_bf16 v[176:191], v[38:41], v[252:255], v[176:191]
    v_mfma_f32_32x32x16_bf16 v[112:127], v[42:45], v[248:251], v[112:127]
    v_mfma_f32_32x32x16_bf16 v[176:191], v[50:53], v[240:243], v[176:191]
    v_mfma_f32_32x32x16_bf16 v[112:127], v[46:49], v[252:255], v[112:127]
    v_mfma_f32_32x32x16_bf16 v[176:191], v[54:57], v[244:247], v[176:191]
    s_lshl_b32 s41, s62, 8
    s_lshl_b32 s42, s63, 7
    s_add_u32 s41, s41, s42
    s_lshl_b32 s42, s64, 5
    s_add_u32 s41, s41, s42
    s_lshl_b32 s41, s41, 4
    s_add_u32 s41, s41, 0x700000
    v_and_b32 v3, 31, v1
    v_lshlrev_b32 v3, 4, v3
    v_lshrrev_b32 v4, 5, v1
    v_lshlrev_b32 v4, 18, v4
    v_add3_u32 v3, v3, v4, s41
    s_nop 7
    s_nop 3
    v_cvt_pk_bf16_f32 v192, v64, v128
    v_cvt_pk_bf16_f32 v193, v80, v144
    v_cvt_pk_bf16_f32 v194, v96, v160
    v_cvt_pk_bf16_f32 v195, v112, v176
    s_mov_b32 s68, 0x0
    buffer_store_dwordx4 v[192:195], v3, s[20:23], s68 offen sc1
    v_cvt_pk_bf16_f32 v196, v65, v129
    v_cvt_pk_bf16_f32 v197, v81, v145
    v_cvt_pk_bf16_f32 v198, v97, v161
    v_cvt_pk_bf16_f32 v199, v113, v177
    s_mov_b32 s68, 0x10000
    buffer_store_dwordx4 v[196:199], v3, s[20:23], s68 offen sc1
    v_cvt_pk_bf16_f32 v200, v66, v130
    v_cvt_pk_bf16_f32 v201, v82, v146
    v_cvt_pk_bf16_f32 v202, v98, v162
    v_cvt_pk_bf16_f32 v203, v114, v178
    s_mov_b32 s68, 0x20000
    buffer_store_dwordx4 v[200:203], v3, s[20:23], s68 offen sc1
    v_cvt_pk_bf16_f32 v204, v67, v131
    v_cvt_pk_bf16_f32 v205, v83, v147
    v_cvt_pk_bf16_f32 v206, v99, v163
    v_cvt_pk_bf16_f32 v207, v115, v179
    s_mov_b32 s68, 0x30000
    buffer_store_dwordx4 v[204:207], v3, s[20:23], s68 offen sc1
    v_cvt_pk_bf16_f32 v208, v68, v132
    v_cvt_pk_bf16_f32 v209, v84, v148
    v_cvt_pk_bf16_f32 v210, v100, v164
    v_cvt_pk_bf16_f32 v211, v116, v180
    s_mov_b32 s68, 0x80000
    buffer_store_dwordx4 v[208:211], v3, s[20:23], s68 offen sc1
    v_cvt_pk_bf16_f32 v212, v69, v133
    v_cvt_pk_bf16_f32 v213, v85, v149
    v_cvt_pk_bf16_f32 v214, v101, v165
    v_cvt_pk_bf16_f32 v215, v117, v181
    s_mov_b32 s68, 0x90000
    buffer_store_dwordx4 v[212:215], v3, s[20:23], s68 offen sc1
    v_cvt_pk_bf16_f32 v216, v70, v134
    v_cvt_pk_bf16_f32 v217, v86, v150
    v_cvt_pk_bf16_f32 v218, v102, v166
    v_cvt_pk_bf16_f32 v219, v118, v182
    s_mov_b32 s68, 0xa0000
    buffer_store_dwordx4 v[216:219], v3, s[20:23], s68 offen sc1
    v_cvt_pk_bf16_f32 v220, v71, v135
    v_cvt_pk_bf16_f32 v221, v87, v151
    v_cvt_pk_bf16_f32 v222, v103, v167
    v_cvt_pk_bf16_f32 v223, v119, v183
    s_mov_b32 s68, 0xb0000
    buffer_store_dwordx4 v[220:223], v3, s[20:23], s68 offen sc1
    v_cvt_pk_bf16_f32 v192, v72, v136
    v_cvt_pk_bf16_f32 v193, v88, v152
    v_cvt_pk_bf16_f32 v194, v104, v168
    v_cvt_pk_bf16_f32 v195, v120, v184
    s_mov_b32 s68, 0x100000
    buffer_store_dwordx4 v[192:195], v3, s[20:23], s68 offen sc1
    v_cvt_pk_bf16_f32 v196, v73, v137
    v_cvt_pk_bf16_f32 v197, v89, v153
    v_cvt_pk_bf16_f32 v198, v105, v169
    v_cvt_pk_bf16_f32 v199, v121, v185
    s_mov_b32 s68, 0x110000
    buffer_store_dwordx4 v[196:199], v3, s[20:23], s68 offen sc1
    v_cvt_pk_bf16_f32 v200, v74, v138
    v_cvt_pk_bf16_f32 v201, v90, v154
    v_cvt_pk_bf16_f32 v202, v106, v170
    v_cvt_pk_bf16_f32 v203, v122, v186
    s_mov_b32 s68, 0x120000
    buffer_store_dwordx4 v[200:203], v3, s[20:23], s68 offen sc1
    v_cvt_pk_bf16_f32 v204, v75, v139
    v_cvt_pk_bf16_f32 v205, v91, v155
    v_cvt_pk_bf16_f32 v206, v107, v171
    v_cvt_pk_bf16_f32 v207, v123, v187
    s_mov_b32 s68, 0x130000
    buffer_store_dwordx4 v[204:207], v3, s[20:23], s68 offen sc1
    v_cvt_pk_bf16_f32 v208, v76, v140
    v_cvt_pk_bf16_f32 v209, v92, v156
    v_cvt_pk_bf16_f32 v210, v108, v172
    v_cvt_pk_bf16_f32 v211, v124, v188
    s_mov_b32 s68, 0x180000
    buffer_store_dwordx4 v[208:211], v3, s[20:23], s68 offen sc1
    v_cvt_pk_bf16_f32 v212, v77, v141
    v_cvt_pk_bf16_f32 v213, v93, v157
    v_cvt_pk_bf16_f32 v214, v109, v173
    v_cvt_pk_bf16_f32 v215, v125, v189
    s_mov_b32 s68, 0x190000
    buffer_store_dwordx4 v[212:215], v3, s[20:23], s68 offen sc1
    v_cvt_pk_bf16_f32 v216, v78, v142
    v_cvt_pk_bf16_f32 v217, v94, v158
    v_cvt_pk_bf16_f32 v218, v110, v174
    v_cvt_pk_bf16_f32 v219, v126, v190
    s_mov_b32 s68, 0x1a0000
    buffer_store_dwordx4 v[216:219], v3, s[20:23], s68 offen sc1
    v_cvt_pk_bf16_f32 v220, v79, v143
    v_cvt_pk_bf16_f32 v221, v95, v159
    v_cvt_pk_bf16_f32 v222, v111, v175
    v_cvt_pk_bf16_f32 v223, v127, v191
    s_mov_b32 s68, 0x1b0000
    buffer_store_dwordx4 v[220:223], v3, s[20:23], s68 offen sc1
    s_waitcnt vmcnt(0)
    s_barrier
    s_cmp_lg_u32 s40, 0
    s_cbranch_scc1 DNOTW0_31
    v_mov_b32 v60, s98
    v_lshlrev_b32 v61, 24, v1
    v_add_u32 v61, s99, v61
    buffer_store_dword v60, v61, s[20:23], 0 offen sc1
    s_waitcnt vmcnt(0)
DNOTW0_31:
    s_endpgm
P1_D_LOADER:
    v_lshrrev_b32 v26, 3, v1
    s_lshl_b32 s41, s65, 5
    v_add_u32 v26, s41, v26
    v_and_b32 v27, 7, v1
    v_lshrrev_b32 v28, 4, v1
    s_movk_i32 s42, 896
    v_add_u32 v29, 0, v28
    v_and_b32 v29, 7, v29
    v_xor_b32 v29, v29, v27
    v_lshlrev_b32 v29, 4, v29
    v_and_b32 v30, 31, v26
    v_lshlrev_b32 v30, 6, v30
    v_lshrrev_b32 v31, 5, v26
    s_lshl_b32 s41, s62, 2
    v_add3_u32 v30, v30, v31, s41
    v_mul_lo_u32 v30, v30, s42
    v_add_u32 v10, v30, v29
    s_lshl_b32 s41, s63, 7
    v_add_u32 v30, s41, v26
    v_mul_lo_u32 v30, v30, s42
    v_add_u32 v14, v30, v29
    v_add_u32 v26, 8, v26
    v_add_u32 v29, 4, v28
    v_and_b32 v29, 7, v29
    v_xor_b32 v29, v29, v27
    v_lshlrev_b32 v29, 4, v29
    v_and_b32 v30, 31, v26
    v_lshlrev_b32 v30, 6, v30
    v_lshrrev_b32 v31, 5, v26
    s_lshl_b32 s41, s62, 2
    v_add3_u32 v30, v30, v31, s41
    v_mul_lo_u32 v30, v30, s42
    v_add_u32 v11, v30, v29
    s_lshl_b32 s41, s63, 7
    v_add_u32 v30, s41, v26
    v_mul_lo_u32 v30, v30, s42
    v_add_u32 v15, v30, v29
    v_add_u32 v26, 8, v26
    v_add_u32 v29, 0, v28
    v_and_b32 v29, 7, v29
    v_xor_b32 v29, v29, v27
    v_lshlrev_b32 v29, 4, v29
    v_and_b32 v30, 31, v26
    v_lshlrev_b32 v30, 6, v30
    v_lshrrev_b32 v31, 5, v26
    s_lshl_b32 s41, s62, 2
    v_add3_u32 v30, v30, v31, s41
    v_mul_lo_u32 v30, v30, s42
    v_add_u32 v12, v30, v29
    s_lshl_b32 s41, s63, 7
    v_add_u32 v30, s41, v26
    v_mul_lo_u32 v30, v30, s42
    v_add_u32 v16, v30, v29
    v_add_u32 v26, 8, v26
    v_add_u32 v29, 4, v28
    v_and_b32 v29, 7, v29
    v_xor_b32 v29, v29, v27
    v_lshlrev_b32 v29, 4, v29
    v_and_b32 v30, 31, v26
    v_lshlrev_b32 v30, 6, v30
    v_lshrrev_b32 v31, 5, v26
    s_lshl_b32 s41, s62, 2
    v_add3_u32 v30, v30, v31, s41
    v_mul_lo_u32 v30, v30, s42
    v_add_u32 v13, v30, v29
    s_lshl_b32 s41, s63, 7
    v_add_u32 v30, s41, v26
    v_mul_lo_u32 v30, v30, s42
    v_add_u32 v17, v30, v29
    s_lshl_b32 s66, s65, 12
    s_lshl_b32 s67, s65, 12
    s_waitcnt lgkmcnt(0)
    s_mov_b32 s8, s44
    s_and_b32 s9, s45, 0xffff
    s_mov_b32 s10, 0x1c0000
    s_mov_b32 s11, 0x20000
    s_mov_b32 s12, s48
    s_and_b32 s13, s49, 0xffff
    s_mov_b32 s14, 0x62000
    s_mov_b32 s15, 0x20000
    s_mov_b32 s16, s50
    s_and_b32 s17, s51, 0xffff
    s_mov_b32 s18, 0x62000
    s_mov_b32 s19, 0x20000
    s_mov_b32 s20, s74
    s_and_b32 s21, s75, 0xffff
    s_mov_b32 s22, 0x1000000
    s_mov_b32 s23, 0x20000
    s_mov_b32 s24, s58
    s_and_b32 s25, s59, 0xffff
    s_mov_b32 s26, 0x380
    s_mov_b32 s27, 0x20000
    s_mov_b32 s32, s56
    s_and_b32 s33, s57, 0xffff
    s_mov_b32 s34, 0x188000
    s_mov_b32 s35, 0x20000
    s_mul_i32 s7, s63, 3
    s_mul_i32 s6, s62, 2
    s_add_u32 s6, s6, s7
    s_mul_i32 s7, s6, 37
    s_lshr_b32 s7, s7, 8
    s_mul_i32 s7, s7, 7
    s_sub_u32 s6, s6, s7
    s_mov_b32 s7, s6
    s_lshl_b32 s68, s6, 7
    s_add_u32 m0, s67, 0x0
    s_nop 0
    buffer_load_dwordx4 v10, s[8:11], s68 offen lds
    s_add_u32 m0, s67, 0x400
    s_nop 0
    buffer_load_dwordx4 v11, s[8:11], s68 offen lds
    s_add_u32 m0, s67, 0x800
    s_nop 0
    buffer_load_dwordx4 v12, s[8:11], s68 offen lds
    s_add_u32 m0, s67, 0xc00
    s_nop 0
    buffer_load_dwordx4 v13, s[8:11], s68 offen lds
    s_add_u32 s6, s6, 1
    s_cmp_eq_u32 s6, 7
    s_cselect_b32 s6, 0, s6
    s_lshl_b32 s68, s7, 7
    s_add_u32 m0, s66, 0x10000
    s_nop 0
    buffer_load_dwordx4 v14, s[12:15], s68 offen lds
    s_add_u32 m0, s66, 0x10400
    s_nop 0
    buffer_load_dwordx4 v15, s[12:15], s68 offen lds
    s_add_u32 m0, s66, 0x10800
    s_nop 0
    buffer_load_dwordx4 v16, s[12:15], s68 offen lds
    s_add_u32 m0, s66, 0x10c00
    s_nop 0
    buffer_load_dwordx4 v17, s[12:15], s68 offen lds
    s_add_u32 m0, s66, 0x14000
    s_nop 0
    buffer_load_dwordx4 v14, s[16:19], s68 offen lds
    s_add_u32 m0, s66, 0x14400
    s_nop 0
    buffer_load_dwordx4 v15, s[16:19], s68 offen lds
    s_add_u32 m0, s66, 0x14800
    s_nop 0
    buffer_load_dwordx4 v16, s[16:19], s68 offen lds
    s_add_u32 m0, s66, 0x14c00
    s_nop 0
    buffer_load_dwordx4 v17, s[16:19], s68 offen lds
    s_add_u32 s7, s7, 1
    s_cmp_eq_u32 s7, 7
    s_cselect_b32 s7, 0, s7
    s_lshl_b32 s68, s6, 7
    s_add_u32 m0, s67, 0x4000
    s_nop 0
    buffer_load_dwordx4 v10, s[8:11], s68 offen lds
    s_add_u32 m0, s67, 0x4400
    s_nop 0
    buffer_load_dwordx4 v11, s[8:11], s68 offen lds
    s_add_u32 m0, s67, 0x4800
    s_nop 0
    buffer_load_dwordx4 v12, s[8:11], s68 offen lds
    s_add_u32 m0, s67, 0x4c00
    s_nop 0
    buffer_load_dwordx4 v13, s[8:11], s68 offen lds
    s_add_u32 s6, s6, 1
    s_cmp_eq_u32 s6, 7
    s_cselect_b32 s6, 0, s6
    s_lshl_b32 s68, s7, 7
    s_add_u32 m0, s66, 0x18000
    s_nop 0
    buffer_load_dwordx4 v14, s[12:15], s68 offen lds
    s_add_u32 m0, s66, 0x18400
    s_nop 0
    buffer_load_dwordx4 v15, s[12:15], s68 offen lds
    s_add_u32 m0, s66, 0x18800
    s_nop 0
    buffer_load_dwordx4 v16, s[12:15], s68 offen lds
    s_add_u32 m0, s66, 0x18c00
    s_nop 0
    buffer_load_dwordx4 v17, s[12:15], s68 offen lds
    s_add_u32 m0, s66, 0x1c000
    s_nop 0
    buffer_load_dwordx4 v14, s[16:19], s68 offen lds
    s_add_u32 m0, s66, 0x1c400
    s_nop 0
    buffer_load_dwordx4 v15, s[16:19], s68 offen lds
    s_add_u32 m0, s66, 0x1c800
    s_nop 0
    buffer_load_dwordx4 v16, s[16:19], s68 offen lds
    s_add_u32 m0, s66, 0x1cc00
    s_nop 0
    buffer_load_dwordx4 v17, s[16:19], s68 offen lds
    s_add_u32 s7, s7, 1
    s_cmp_eq_u32 s7, 7
    s_cselect_b32 s7, 0, s7
    s_lshl_b32 s68, s6, 7
    s_add_u32 m0, s67, 0x8000
    s_nop 0
    buffer_load_dwordx4 v10, s[8:11], s68 offen lds
    s_add_u32 m0, s67, 0x8400
    s_nop 0
    buffer_load_dwordx4 v11, s[8:11], s68 offen lds
    s_add_u32 m0, s67, 0x8800
    s_nop 0
    buffer_load_dwordx4 v12, s[8:11], s68 offen lds
    s_add_u32 m0, s67, 0x8c00
    s_nop 0
    buffer_load_dwordx4 v13, s[8:11], s68 offen lds
    s_add_u32 s6, s6, 1
    s_cmp_eq_u32 s6, 7
    s_cselect_b32 s6, 0, s6
    s_waitcnt vmcnt(16)
    s_barrier
    s_lshl_b32 s68, s7, 7
    s_add_u32 m0, s66, 0x20000
    s_nop 0
    buffer_load_dwordx4 v14, s[12:15], s68 offen lds
    s_add_u32 m0, s66, 0x20400
    s_nop 0
    buffer_load_dwordx4 v15, s[12:15], s68 offen lds
    s_add_u32 m0, s66, 0x20800
    s_nop 0
    buffer_load_dwordx4 v16, s[12:15], s68 offen lds
    s_add_u32 m0, s66, 0x20c00
    s_nop 0
    buffer_load_dwordx4 v17, s[12:15], s68 offen lds
    s_add_u32 m0, s66, 0x24000
    s_nop 0
    buffer_load_dwordx4 v14, s[16:19], s68 offen lds
    s_add_u32 m0, s66, 0x24400
    s_nop 0
    buffer_load_dwordx4 v15, s[16:19], s68 offen lds
    s_add_u32 m0, s66, 0x24800
    s_nop 0
    buffer_load_dwordx4 v16, s[16:19], s68 offen lds
    s_add_u32 m0, s66, 0x24c00
    s_nop 0
    buffer_load_dwordx4 v17, s[16:19], s68 offen lds
    s_add_u32 s7, s7, 1
    s_cmp_eq_u32 s7, 7
    s_cselect_b32 s7, 0, s7
    s_waitcnt vmcnt(12)
    s_barrier
    s_lshl_b32 s68, s6, 7
    s_add_u32 m0, s67, 0xc000
    s_nop 0
    buffer_load_dwordx4 v10, s[8:11], s68 offen lds
    s_add_u32 m0, s67, 0xc400
    s_nop 0
    buffer_load_dwordx4 v11, s[8:11], s68 offen lds
    s_add_u32 m0, s67, 0xc800
    s_nop 0
    buffer_load_dwordx4 v12, s[8:11], s68 offen lds
    s_add_u32 m0, s67, 0xcc00
    s_nop 0
    buffer_load_dwordx4 v13, s[8:11], s68 offen lds
    s_add_u32 s6, s6, 1
    s_cmp_eq_u32 s6, 7
    s_cselect_b32 s6, 0, s6
    s_lshl_b32 s41, s62, 1
    s_add_u32 s41, s41, s63
    s_lshl_b32 s41, s41, 2
    s_add_u32 s41, s41, s65
    s_mul_i32 s41, s41, 98
    v_add_u32 v100, s41, v1
    v_lshlrev_b32 v100, 7, v100
    buffer_load_dword v101, v100, s[32:35], 0 offen
    v_add_u32 v100, 8192, v100
    v_cmp_gt_u32 vcc, 34, v1
    v_mov_b32 v102, 0x7fffffff
    s_nop 0
    v_cndmask_b32 v100, v102, v100, vcc
    buffer_load_dword v103, v100, s[32:35], 0 offen
    s_barrier
    s_lshl_b32 s68, s7, 7
    s_add_u32 m0, s66, 0x10000
    s_nop 0
    buffer_load_dwordx4 v14, s[12:15], s68 offen lds
    s_add_u32 m0, s66, 0x10400
    s_nop 0
    buffer_load_dwordx4 v15, s[12:15], s68 offen lds
    s_add_u32 m0, s66, 0x10800
    s_nop 0
    buffer_load_dwordx4 v16, s[12:15], s68 offen lds
    s_add_u32 m0, s66, 0x10c00
    s_nop 0
    buffer_load_dwordx4 v17, s[12:15], s68 offen lds
    s_add_u32 m0, s66, 0x14000
    s_nop 0
    buffer_load_dwordx4 v14, s[16:19], s68 offen lds
    s_add_u32 m0, s66, 0x14400
    s_nop 0
    buffer_load_dwordx4 v15, s[16:19], s68 offen lds
    s_add_u32 m0, s66, 0x14800
    s_nop 0
    buffer_load_dwordx4 v16, s[16:19], s68 offen lds
    s_add_u32 m0, s66, 0x14c00
    s_nop 0
    buffer_load_dwordx4 v17, s[16:19], s68 offen lds
    s_add_u32 s7, s7, 1
    s_cmp_eq_u32 s7, 7
    s_cselect_b32 s7, 0, s7
    s_waitcnt vmcnt(14)
    s_barrier
    s_lshl_b32 s68, s6, 7
    s_add_u32 m0, s67, 0x0
    s_nop 0
    buffer_load_dwordx4 v10, s[8:11], s68 offen lds
    s_add_u32 m0, s67, 0x400
    s_nop 0
    buffer_load_dwordx4 v11, s[8:11], s68 offen lds
    s_add_u32 m0, s67, 0x800
    s_nop 0
    buffer_load_dwordx4 v12, s[8:11], s68 offen lds
    s_add_u32 m0, s67, 0xc00
    s_nop 0
    buffer_load_dwordx4 v13, s[8:11], s68 offen lds
    s_add_u32 s6, s6, 1
    s_cmp_eq_u32 s6, 7
    s_cselect_b32 s6, 0, s6
    s_barrier
    s_lshl_b32 s68, s7, 7
    s_add_u32 m0, s66, 0x18000
    s_nop 0
    buffer_load_dwordx4 v14, s[12:15], s68 offen lds
    s_add_u32 m0, s66, 0x18400
    s_nop 0
    buffer_load_dwordx4 v15, s[12:15], s68 offen lds
    s_add_u32 m0, s66, 0x18800
    s_nop 0
    buffer_load_dwordx4 v16, s[12:15], s68 offen lds
    s_add_u32 m0, s66, 0x18c00
    s_nop 0
    buffer_load_dwordx4 v17, s[12:15], s68 offen lds
    s_add_u32 m0, s66, 0x1c000
    s_nop 0
    buffer_load_dwordx4 v14, s[16:19], s68 offen lds
    s_add_u32 m0, s66, 0x1c400
    s_nop 0
    buffer_load_dwordx4 v15, s[16:19], s68 offen lds
    s_add_u32 m0, s66, 0x1c800
    s_nop 0
    buffer_load_dwordx4 v16, s[16:19], s68 offen lds
    s_add_u32 m0, s66, 0x1cc00
    s_nop 0
    buffer_load_dwordx4 v17, s[16:19], s68 offen lds
    s_add_u32 s7, s7, 1
    s_cmp_eq_u32 s7, 7
    s_cselect_b32 s7, 0, s7
    s_waitcnt vmcnt(12)
    s_barrier
    s_lshl_b32 s68, s6, 7
    s_add_u32 m0, s67, 0x4000
    s_nop 0
    buffer_load_dwordx4 v10, s[8:11], s68 offen lds
    s_add_u32 m0, s67, 0x4400
    s_nop 0
    buffer_load_dwordx4 v11, s[8:11], s68 offen lds
    s_add_u32 m0, s67, 0x4800
    s_nop 0
    buffer_load_dwordx4 v12, s[8:11], s68 offen lds
    s_add_u32 m0, s67, 0x4c00
    s_nop 0
    buffer_load_dwordx4 v13, s[8:11], s68 offen lds
    s_add_u32 s6, s6, 1
    s_cmp_eq_u32 s6, 7
    s_cselect_b32 s6, 0, s6
    s_barrier
    s_lshl_b32 s68, s7, 7
    s_add_u32 m0, s66, 0x20000
    s_nop 0
    buffer_load_dwordx4 v14, s[12:15], s68 offen lds
    s_add_u32 m0, s66, 0x20400
    s_nop 0
    buffer_load_dwordx4 v15, s[12:15], s68 offen lds
    s_add_u32 m0, s66, 0x20800
    s_nop 0
    buffer_load_dwordx4 v16, s[12:15], s68 offen lds
    s_add_u32 m0, s66, 0x20c00
    s_nop 0
    buffer_load_dwordx4 v17, s[12:15], s68 offen lds
    s_add_u32 m0, s66, 0x24000
    s_nop 0
    buffer_load_dwordx4 v14, s[16:19], s68 offen lds
    s_add_u32 m0, s66, 0x24400
    s_nop 0
    buffer_load_dwordx4 v15, s[16:19], s68 offen lds
    s_add_u32 m0, s66, 0x24800
    s_nop 0
    buffer_load_dwordx4 v16, s[16:19], s68 offen lds
    s_add_u32 m0, s66, 0x24c00
    s_nop 0
    buffer_load_dwordx4 v17, s[16:19], s68 offen lds
    s_add_u32 s7, s7, 1
    s_cmp_eq_u32 s7, 7
    s_cselect_b32 s7, 0, s7
    s_waitcnt vmcnt(12)
    s_barrier
    s_lshl_b32 s68, s6, 7
    s_add_u32 m0, s67, 0x8000
    s_nop 0
    buffer_load_dwordx4 v10, s[8:11], s68 offen lds
    s_add_u32 m0, s67, 0x8400
    s_nop 0
    buffer_load_dwordx4 v11, s[8:11], s68 offen lds
    s_add_u32 m0, s67, 0x8800
    s_nop 0
    buffer_load_dwordx4 v12, s[8:11], s68 offen lds
    s_add_u32 m0, s67, 0x8c00
    s_nop 0
    buffer_load_dwordx4 v13, s[8:11], s68 offen lds
    s_add_u32 s6, s6, 1
    s_cmp_eq_u32 s6, 7
    s_cselect_b32 s6, 0, s6
    s_barrier
    s_lshl_b32 s68, s7, 7
    s_add_u32 m0, s66, 0x10000
    s_nop 0
    buffer_load_dwordx4 v14, s[12:15], s68 offen lds
    s_add_u32 m0, s66, 0x10400
    s_nop 0
    buffer_load_dwordx4 v15, s[12:15], s68 offen lds
    s_add_u32 m0, s66, 0x10800
    s_nop 0
    buffer_load_dwordx4 v16, s[12:15], s68 offen lds
    s_add_u32 m0, s66, 0x10c00
    s_nop 0
    buffer_load_dwordx4 v17, s[12:15], s68 offen lds
    s_add_u32 m0, s66, 0x14000
    s_nop 0
    buffer_load_dwordx4 v14, s[16:19], s68 offen lds
    s_add_u32 m0, s66, 0x14400
    s_nop 0
    buffer_load_dwordx4 v15, s[16:19], s68 offen lds
    s_add_u32 m0, s66, 0x14800
    s_nop 0
    buffer_load_dwordx4 v16, s[16:19], s68 offen lds
    s_add_u32 m0, s66, 0x14c00
    s_nop 0
    buffer_load_dwordx4 v17, s[16:19], s68 offen lds
    s_add_u32 s7, s7, 1
    s_cmp_eq_u32 s7, 7
    s_cselect_b32 s7, 0, s7
    s_waitcnt vmcnt(12)
    s_barrier
    v_and_b32 v26, 31, v1
    v_lshrrev_b32 v27, 5, v1
    v_lshlrev_b32 v27, 8, v27
    s_lshl_b32 s41, s62, 2
    s_add_u32 s41, s41, s65
    v_add_u32 v27, s41, v27
    s_mov_b32 s42, 0x3a000000
    v_add_u32 v28, 0, v27
    v_mul_u32_u24 v28, v28, v26
    v_and_b32 v28, 0x7ff, v28
    v_cvt_f32_u32 v28, v28
    v_mul_f32 v28, s42, v28
    v_cos_f32 v30, v28
    v_sin_f32 v32, v28
    v_add_u32 v28, 64, v27
    v_mul_u32_u24 v28, v28, v26
    v_and_b32 v28, 0x7ff, v28
    v_cvt_f32_u32 v28, v28
    v_mul_f32 v28, s42, v28
    v_cos_f32 v31, v28
    v_sin_f32 v33, v28
    s_nop 0
    v_cvt_pk_bf16_f32 v64, v30, v31
    v_cvt_pk_bf16_f32 v72, v32, v33
    v_xor_b32 v80, 0x80008000, v72
    v_add_u32 v28, 128, v27
    v_mul_u32_u24 v28, v28, v26
    v_and_b32 v28, 0x7ff, v28
    v_cvt_f32_u32 v28, v28
    v_mul_f32 v28, s42, v28
    v_cos_f32 v30, v28
    v_sin_f32 v32, v28
    v_add_u32 v28, 192, v27
    v_mul_u32_u24 v28, v28, v26
    v_and_b32 v28, 0x7ff, v28
    v_cvt_f32_u32 v28, v28
    v_mul_f32 v28, s42, v28
    v_cos_f32 v31, v28
    v_sin_f32 v33, v28
    s_nop 0
    v_cvt_pk_bf16_f32 v65, v30, v31
    v_cvt_pk_bf16_f32 v73, v32, v33
    v_xor_b32 v81, 0x80008000, v73
    v_add_u32 v28, 512, v27
    v_mul_u32_u24 v28, v28, v26
    v_and_b32 v28, 0x7ff, v28
    v_cvt_f32_u32 v28, v28
    v_mul_f32 v28, s42, v28
    v_cos_f32 v30, v28
    v_sin_f32 v32, v28
    v_add_u32 v28, 576, v27
    v_mul_u32_u24 v28, v28, v26
    v_and_b32 v28, 0x7ff, v28
    v_cvt_f32_u32 v28, v28
    v_mul_f32 v28, s42, v28
    v_cos_f32 v31, v28
    v_sin_f32 v33, v28
    s_nop 0
    v_cvt_pk_bf16_f32 v66, v30, v31
    v_cvt_pk_bf16_f32 v74, v32, v33
    v_xor_b32 v82, 0x80008000, v74
    v_add_u32 v28, 640, v27
    v_mul_u32_u24 v28, v28, v26
    v_and_b32 v28, 0x7ff, v28
    v_cvt_f32_u32 v28, v28
    v_mul_f32 v28, s42, v28
    v_cos_f32 v30, v28
    v_sin_f32 v32, v28
    v_add_u32 v28, 704, v27
    v_mul_u32_u24 v28, v28, v26
    v_and_b32 v28, 0x7ff, v28
    v_cvt_f32_u32 v28, v28
    v_mul_f32 v28, s42, v28
    v_cos_f32 v31, v28
    v_sin_f32 v33, v28
    s_nop 0
    v_cvt_pk_bf16_f32 v67, v30, v31
    v_cvt_pk_bf16_f32 v75, v32, v33
    v_xor_b32 v83, 0x80008000, v75
    v_add_u32 v28, 1024, v27
    v_mul_u32_u24 v28, v28, v26
    v_and_b32 v28, 0x7ff, v28
    v_cvt_f32_u32 v28, v28
    v_mul_f32 v28, s42, v28
    v_cos_f32 v30, v28
    v_sin_f32 v32, v28
    v_add_u32 v28, 1088, v27
    v_mul_u32_u24 v28, v28, v26
    v_and_b32 v28, 0x7ff, v28
    v_cvt_f32_u32 v28, v28
    v_mul_f32 v28, s42, v28
    v_cos_f32 v31, v28
    v_sin_f32 v33, v28
    s_nop 0
    v_cvt_pk_bf16_f32 v68, v30, v31
    v_cvt_pk_bf16_f32 v76, v32, v33
    v_xor_b32 v84, 0x80008000, v76
    v_add_u32 v28, 1152, v27
    v_mul_u32_u24 v28, v28, v26
    v_and_b32 v28, 0x7ff, v28
    v_cvt_f32_u32 v28, v28
    v_mul_f32 v28, s42, v28
    v_cos_f32 v30, v28
    v_sin_f32 v32, v28
    v_add_u32 v28, 1216, v27
    v_mul_u32_u24 v28, v28, v26
    v_and_b32 v28, 0x7ff, v28
    v_cvt_f32_u32 v28, v28
    v_mul_f32 v28, s42, v28
    v_cos_f32 v31, v28
    v_sin_f32 v33, v28
    s_nop 0
    v_cvt_pk_bf16_f32 v69, v30, v31
    v_cvt_pk_bf16_f32 v77, v32, v33
    v_xor_b32 v85, 0x80008000, v77
    v_add_u32 v28, 1536, v27
    v_mul_u32_u24 v28, v28, v26
    v_and_b32 v28, 0x7ff, v28
    v_cvt_f32_u32 v28, v28
    v_mul_f32 v28, s42, v28
    v_cos_f32 v30, v28
    v_sin_f32 v32, v28
    v_add_u32 v28, 1600, v27
    v_mul_u32_u24 v28, v28, v26
    v_and_b32 v28, 0x7ff, v28
    v_cvt_f32_u32 v28, v28
    v_mul_f32 v28, s42, v28
    v_cos_f32 v31, v28
    v_sin_f32 v33, v28
    s_nop 0
    v_cvt_pk_bf16_f32 v70, v30, v31
    v_cvt_pk_bf16_f32 v78, v32, v33
    v_xor_b32 v86, 0x80008000, v78
    v_add_u32 v28, 1664, v27
    v_mul_u32_u24 v28, v28, v26
    v_and_b32 v28, 0x7ff, v28
    v_cvt_f32_u32 v28, v28
    v_mul_f32 v28, s42, v28
    v_cos_f32 v30, v28
    v_sin_f32 v32, v28
    v_add_u32 v28, 1728, v27
    v_mul_u32_u24 v28, v28, v26
    v_and_b32 v28, 0x7ff, v28
    v_cvt_f32_u32 v28, v28
    v_mul_f32 v28, s42, v28
    v_cos_f32 v31, v28
    v_sin_f32 v33, v28
    s_nop 0
    v_cvt_pk_bf16_f32 v71, v30, v31
    v_cvt_pk_bf16_f32 v79, v32, v33
    v_xor_b32 v87, 0x80008000, v79
    s_barrier
    s_waitcnt vmcnt(0)
    s_barrier
    s_waitcnt vmcnt(0)
    s_barrier
    s_barrier
    v_lshlrev_b32 v2, 4, v1
    s_mul_i32 s41, s65, 6144
    v_add_u32 v2, s41, v2
    ds_write_b128 v2, v[64:67] offset:0
    ds_write_b128 v2, v[68:71] offset:1024
    ds_write_b128 v2, v[72:75] offset:2048
    ds_write_b128 v2, v[76:79] offset:3072
    ds_write_b128 v2, v[80:83] offset:4096
    ds_write_b128 v2, v[84:87] offset:5120
    s_waitcnt lgkmcnt(0)
    s_barrier
    s_waitcnt vmcnt(0)
    s_barrier
    s_endpgm
KF_END:
    s_endpgm
KF_CODE_END:
.section .rodata,"a"
.p2align 6
.amdhsa_kernel gated_mix__spectral_fnet__glu_gated_glu__prompt_kernel
  .amdhsa_next_free_vgpr 256
  .amdhsa_next_free_sgpr 102
  .amdhsa_accum_offset 256
  .amdhsa_group_segment_fixed_size 0
  .amdhsa_kernarg_size 104
  .amdhsa_user_sgpr_count 2
  .amdhsa_user_sgpr_kernarg_segment_ptr 1
  .amdhsa_system_sgpr_workgroup_id_x 1
.end_amdhsa_kernel
```
